```python
import torch

def _softmax(x, axis=-1):
    return torch.softmax(x, dim=axis)
def _gelu(x):
    return torch.nn.functional.gelu(x, approximate="tanh")
def _silu(x):
    return torch.nn.functional.silu(x)
def _sigmoid(x):
    return torch.sigmoid(x)
def _layernorm(x, axis=-1, eps=1e-5):
    m = x.mean(dim=axis, keepdim=True)
    v = x.var(dim=axis, keepdim=True, unbiased=False)
    return (x - m) / torch.sqrt(v + eps)
def _scatter_add(tgt, idx, src, axis=0):
    return tgt.clone().index_add_(axis, idx, src)
def _segment_sum(src, seg, n):
    out = torch.zeros((n,) + src.shape[1:], dtype=src.dtype)
    return out.index_add_(0, seg, src)
def _pad(x, pw):
    flat = tuple(v for pair in reversed(pw) for v in pair)
    return torch.nn.functional.pad(x, flat)

kernel_name = 'gated_mix__linear_attn_block__dense_activation_gelu__prompt'

def setup_inputs():

    _w = (lambda a: (lambda t: t.to(torch.bfloat16) if t.is_floating_point() else t)(torch.as_tensor(a)))
    def _A_setup():
        B, S, D = 1, 2048, 512
        return {
            "x": _w((lambda *s: torch.randn(*s, dtype=torch.bfloat16) * 0.05)(B, S, D)),
            "wqkv": _w((lambda *s: torch.randn(*s, dtype=torch.bfloat16) * 0.8)(D, 3 * D)),
            "wo": _w((lambda *s: torch.randn(*s, dtype=torch.bfloat16) * 0.05)(D, D)),
        }
    _A_in = _A_setup()

    def _B_setup():
        B, S, D, F = 1, 2048, 512, 1376
        return {
            "x": _w((lambda *s: torch.randn(*s, dtype=torch.bfloat16) * 0.05)(B, S, D)),
            "w1": _w((lambda *s: torch.randn(*s, dtype=torch.bfloat16) * 3.2)(D, F) * (D ** -0.5)),
            "b1": _w((lambda *s: torch.randn(*s, dtype=torch.bfloat16) * 3.2)(F) * 0.01),
            "w2": _w((lambda *s: torch.randn(*s, dtype=torch.bfloat16) * 0.4)(F, D) * (F ** -0.5)),
            "b2": _w((lambda *s: torch.randn(*s, dtype=torch.bfloat16) * 0.8)(D) * 0.01),
        }
    _B_in = _B_setup()

    return {
        "A_x": _A_in["x"],
        "A_wqkv": _A_in["wqkv"],
        "A_wo": _A_in["wo"],
        "B_x": _B_in["x"],
        "B_w1": _B_in["w1"],
        "B_b1": _B_in["b1"],
        "B_w2": _B_in["w2"],
        "B_b2": _B_in["b2"],
        "gate_w": _w((lambda *s: torch.randn(*s, dtype=torch.bfloat16) * 0.05)(512) * 16.0),
    }

def reference(A_x, A_wqkv, A_wo, B_x, B_w1, B_b1, B_w2, B_b2, gate_w):
    def _A_ref(x, wqkv, wo):
        B, S, D = x.shape
        H = 32; Dh = D // H
        qkv = (lambda x, *d: x.permute(*d))((x @ wqkv).reshape(B, S, 3, H, Dh), 2, 0, 3, 1, 4)
        q, k, v = qkv[0], qkv[1], qkv[2]
        phi = lambda t: torch.where(t > 0, t + 1, torch.exp(t)) + 1e-6
        pq, pk = phi(q), phi(k)
        kv = torch.einsum("bhsd,bhse->bhde", pk, v)
        z = torch.einsum("bhsd->bhd", pk)
        num = torch.einsum("bhqd,bhde->bhqe", pq, kv)
        den = torch.einsum("bhqd,bhd->bhq", pq, z)[..., None] + 1e-6
        o = num / den
        return (lambda x, *d: x.permute(*d))(o, 0, 2, 1, 3).reshape(B, S, D) @ wo

    def _B_ref(x, w1, b1, w2, b2):
        h = torch.einsum("bsd,df->bsf", x, w1) + b1
        h = _gelu(h)
        return torch.einsum("bsf,fd->bsd", h, w2) + b2

    x = A_x
    g = _sigmoid((x * gate_w).sum(-1, keepdims=True))
    a = _A_ref(x, A_wqkv, A_wo)
    b = _B_ref(x, B_w1, B_b1, B_w2, B_b2)
    return g * a + (1 - g) * b
```

```asm
; @launch grid=(256,1,1) block=(512,1,1) lds=163840
.amdgcn_target "amdgcn-amd-amdhsa--gfx950"
.text
.globl gated_mix__linear_attn_block__dense_activation_gelu__prompt_kernel
.p2align 8
.type gated_mix__linear_attn_block__dense_activation_gelu__prompt_kernel,@function
gated_mix__linear_attn_block__dense_activation_gelu__prompt_kernel:
    s_cmp_ge_u32 s2, 256
    s_cbranch_scc1 L_end
    s_load_dwordx2 s[8:9], s[0:1], 0
    s_bfe_u32 s52, s2, 0x10003
    s_mul_i32 s66, s52, 24
    s_add_u32 s66, s66, 8
    s_load_dwordx2 s[12:13], s[0:1], s66
    s_load_dwordx2 s[24:25], s[0:1], 88
    s_load_dwordx2 s[28:29], s[0:1], 80
    v_lshrrev_b32 v240, 6, v0
    v_and_b32 v1, 63, v0
    s_lshr_b32 s68, s2, 5
    v_readfirstlane_b32 s48, v240
    s_and_b32 s67, s2, 1
    s_lshl3_add_u32 s50, s67, s68
    s_bfe_u32 s67, s2, 0x20003
    s_lshl1_add_u32 s53, s67, s68
    s_and_b32 s53, s53, 3
    s_mul_i32 s53, s53, 2
    s_mul_i32 s67, s2, 1
    s_add_u32 s53, s53, s67
    s_and_b32 s53, s53, 7
    s_and_b32 s67, s2, 6
    s_xor_b32 s67, s67, 2
    s_bfe_u32 s68, s2, 0x10004
    s_add_u32 s51, s67, s68
    s_and_b32 s67, s2, 0x1e
    s_cmp_eq_u32 s67, 28
    s_cselect_b32 s59, 1, 0
    s_and_b32 s49, s48, 3
    s_lshl_b32 s55, s49, 12
    s_lshl_b32 s56, s49, 11
    v_lshlrev_b32 v2, 4, v1
    v_lshrrev_b32 v240, 3, v1
    v_and_b32 v241, 7, v1
    s_mov_b32 s26, 0x904080
    s_mov_b32 s27, 0x20000
    s_mov_b32 s30, 256
    s_mov_b32 s31, 0x20000
    s_cmp_lt_u32 s48, 4
    s_cbranch_scc1 L_G0
    v_lshrrev_b32 v242, 1, v240
    v_xor_b32 v242, v241, v242
    v_lshlrev_b32 v242, 4, v242
    s_lshl2_add_u32 s67, s50, s49
    s_lshl_b32 s67, s67, 15
    v_lshl_add_u32 v3, v240, 10, v242
    v_add_u32 v3, s67, v3
    v_xor_b32 v4, 64, v3
    v_add_u32 v4, 0x2000, v4
    v_add_u32 v5, 0x4000, v3
    v_add_u32 v6, 0x4000, v4
    v_and_b32 v242, 2, v240
    v_xor_b32 v242, v241, v242
    v_lshlrev_b32 v242, 4, v242
    v_xor_b32 v243, 64, v242
    s_lshl_b32 s69, s51, 7
    s_add_u32 s70, s69, 1024
    s_mul_i32 s69, s69, 3
    s_movk_i32 s67, 3072
    s_movk_i32 s71, 0x400
    s_cmp_eq_u32 s52, 1
    s_cselect_b32 s67, 2752, s67
    s_cselect_b32 s69, s69, s70
    s_cselect_b32 s70, 0x80, s71
    s_movk_i32 s71, 0xfc00
    s_cselect_b32 s71, 0x100, s71
    s_mov_b32 s14, 0x180000
    s_cselect_b32 s14, 1409024, s14
    s_cmp_eq_u32 s59, 1
    s_cselect_b32 s70, 0x7f000000, s70
    s_cselect_b32 s71, 0x7f000000, s71
    s_cselect_b32 s68, 24, 0
    s_lshl_b32 s66, s49, 4
    v_add_u32 v244, s66, v240
    v_mul_lo_u32 v244, v244, s67
    s_lshl_b32 s54, s67, 6
    s_lshl3_add_u32 s66, s67, s69
    v_add3_u32 v7, v244, v242, s69
    v_add3_u32 v8, v244, v243, s66
    v_add_u32 v9, s70, v7
    v_add_u32 v10, s70, v8
    v_add_u32 v11, s71, v7
    v_add_u32 v12, s71, v8
    v_and_b32 v242, 64, v242
    v_and_b32 v243, 64, v243
    v_lshlrev_b32 v242, s68, v242
    v_lshlrev_b32 v243, s68, v243
    v_and_b32 v242, 0x40000000, v242
    v_and_b32 v243, 0x40000000, v243
    v_add_u32 v7, v242, v7
    v_add_u32 v8, v243, v8
    s_mov_b32 s10, 0x200000
    s_mov_b32 s11, 0x20000
    s_mov_b32 s15, 0x20000
    s_add_u32 m0, s55, 0
    s_add_u32 s66, s53, 0
    s_and_b32 s66, s66, 7
    s_lshl_b32 s67, s66, 7
    s_mul_i32 s68, s66, s54
    s_waitcnt lgkmcnt(0)
    buffer_load_dwordx4 v3, s[8:11], s67 offen lds
    s_add_u32 m0, s56, 16384
    s_nop 0
    buffer_load_dwordx4 v7, s[12:15], s68 offen lds
    s_add_u32 m0, s55, 1024
    s_nop 0
    buffer_load_dwordx4 v4, s[8:11], s67 offen lds
    s_add_u32 m0, s56, 17408
    s_nop 0
    buffer_load_dwordx4 v8, s[12:15], s68 offen lds
    s_add_u32 m0, s55, 2048
    s_nop 0
    buffer_load_dwordx4 v5, s[8:11], s67 offen lds
    s_add_u32 m0, s56, 24576
    s_nop 0
    buffer_load_dwordx4 v9, s[12:15], s68 offen lds
    s_add_u32 m0, s55, 3072
    s_nop 0
    buffer_load_dwordx4 v6, s[8:11], s67 offen lds
    s_add_u32 m0, s56, 25600
    s_nop 0
    buffer_load_dwordx4 v10, s[12:15], s68 offen lds
    s_load_dwordx2 s[16:17], s[0:1], 40
    s_load_dwordx2 s[20:21], s[0:1], 64
    s_load_dwordx2 s[32:33], s[0:1], 48
    s_load_dwordx2 s[36:37], s[0:1], 16
    s_load_dwordx2 s[44:45], s[0:1], 56
    s_load_dwordx2 s[40:41], s[0:1], 72
    s_cmp_eq_u32 s59, 0
    s_cbranch_scc1 L_nogf
    s_mov_b32 s22, 1024
    s_mov_b32 s23, 0x20000
    v_and_b32 v242, 48, v1
    s_add_u32 s66, s53, 0
    s_and_b32 s66, s66, 7
    s_lshl_b32 s66, s66, 7
    s_waitcnt lgkmcnt(0)
    buffer_load_dwordx4 v[176:179], v242, s[20:23], s66 offen offset:0
    buffer_load_dwordx4 v[180:183], v242, s[20:23], s66 offen offset:64
    s_add_u32 s66, s53, 1
    s_and_b32 s66, s66, 7
    s_lshl_b32 s66, s66, 7
    buffer_load_dwordx4 v[184:187], v242, s[20:23], s66 offen offset:0
    buffer_load_dwordx4 v[188:191], v242, s[20:23], s66 offen offset:64
    s_add_u32 s66, s53, 2
    s_and_b32 s66, s66, 7
    s_lshl_b32 s66, s66, 7
    buffer_load_dwordx4 v[192:195], v242, s[20:23], s66 offen offset:0
    buffer_load_dwordx4 v[196:199], v242, s[20:23], s66 offen offset:64
    s_add_u32 s66, s53, 3
    s_and_b32 s66, s66, 7
    s_lshl_b32 s66, s66, 7
    buffer_load_dwordx4 v[200:203], v242, s[20:23], s66 offen offset:0
    buffer_load_dwordx4 v[204:207], v242, s[20:23], s66 offen offset:64
    s_add_u32 s66, s53, 4
    s_and_b32 s66, s66, 7
    s_lshl_b32 s66, s66, 7
    buffer_load_dwordx4 v[208:211], v242, s[20:23], s66 offen offset:0
    buffer_load_dwordx4 v[212:215], v242, s[20:23], s66 offen offset:64
    s_add_u32 s66, s53, 5
    s_and_b32 s66, s66, 7
    s_lshl_b32 s66, s66, 7
    buffer_load_dwordx4 v[216:219], v242, s[20:23], s66 offen offset:0
    buffer_load_dwordx4 v[220:223], v242, s[20:23], s66 offen offset:64
    s_add_u32 s66, s53, 6
    s_and_b32 s66, s66, 7
    s_lshl_b32 s66, s66, 7
    buffer_load_dwordx4 v[224:227], v242, s[20:23], s66 offen offset:0
    buffer_load_dwordx4 v[228:231], v242, s[20:23], s66 offen offset:64
    s_add_u32 s66, s53, 7
    s_and_b32 s66, s66, 7
    s_lshl_b32 s66, s66, 7
    buffer_load_dwordx4 v[232:235], v242, s[20:23], s66 offen offset:0
    buffer_load_dwordx4 v[236:239], v242, s[20:23], s66 offen offset:64
    s_nop 7
L_nogf:
    s_mov_b32 s18, 2752
    s_mov_b32 s19, 0x20000
    s_mov_b32 s34, 1409024
    s_mov_b32 s35, 0x20000
    s_mov_b32 s38, 524288
    s_mov_b32 s39, 0x20000
    s_mov_b32 s46, 1024
    s_mov_b32 s47, 0x20000
    s_mov_b32 s42, 2097152
    s_mov_b32 s43, 0x20000
    s_and_b32 s66, s2, 7
    s_bfe_u32 s58, s2, 0x30004
    s_xor_b32 s67, s58, s52
    s_and_b32 s67, s67, 1
    s_lshr_b32 s68, s2, 7
    s_lshl1_add_u32 s67, s68, s67
    s_lshl2_add_u32 s57, s66, s67
    s_lshr_b32 s67, s58, 1
    s_lshl1_add_u32 s67, s68, s67
    s_and_b32 s67, s67, 3
    s_lshr_b32 s69, s49, 1
    s_lshl1_add_u32 s67, s67, s69
    s_lshl_b32 s83, s67, 12
    s_cmp_eq_u32 s67, 7
    s_cselect_b32 s67, 0, s67
    s_mul_i32 s72, s67, 12288
    v_and_b32 v242, 6, v240
    v_xor_b32 v242, v242, v241
    v_lshlrev_b32 v242, 4, v242
    v_lshl_add_u32 v13, v240, 10, v242
    s_lshl_b32 s66, s58, 7
    s_and_b32 s68, s49, 1
    s_lshl_b32 s68, s68, 15
    s_add_u32 s68, s68, s66
    v_add_u32 v13, s68, v13
    v_add_u32 v14, 0x2000, v13
    v_and_b32 v242, 15, v1
    v_lshrrev_b32 v243, 4, v1
    v_lshlrev_b32 v245, 3, v243
    s_and_b32 s68, s49, 2
    s_lshl_b32 s68, s68, 5
    s_add_u32 s66, s66, s68
    v_add_u32 v28, s66, v245
    v_bfe_u32 v244, v1, 1, 1
    v_and_b32 v245, 3, v240
    v_lshl_add_u32 v244, v245, 1, v244
    v_lshlrev_b32 v244, 4, v244
    v_and_b32 v245, 1, v1
    v_lshl_add_u32 v244, v245, 3, v244
    v_lshrrev_b32 v245, 2, v1
    v_lshl_add_u32 v245, v245, 7, v244
    v_add_u32 v245, s55, v245
    v_xor_b32 v21, s68, v245
    v_xor_b32 v22, 32, v21
    v_xor_b32 v23, 64, v21
    v_xor_b32 v24, 0x60, v21
    s_lshl1_add_u32 s70, s57, 1
    s_mul_i32 s66, s70, 122880
    s_and_b32 s67, s49, 1
    s_lshl_b32 s68, s67, 11
    s_add_u32 s66, s66, s68
    s_lshl_b32 s68, s67, 10
    v_xor_b32 v25, s68, v2
    v_xor_b32 v26, 0x400, v25
    v_add_u32 v25, s66, v25
    v_add_u32 v26, s66, v26
    s_lshr_b32 s66, s70, 3
    s_mul_i32 s66, s66, 122880
    s_and_b32 s70, s70, 7
    s_lshl1_add_u32 s70, s70, s67
    s_lshl_b32 s70, s70, 8
    s_add_u32 s66, s66, s70
    s_add_u32 s66, s66, 7864320
    v_lshl_add_u32 v27, v1, 2, s66
    s_mov_b32 s60, 0x4000
    s_cmp_lt_u32 s49, 3
    s_cselect_b32 s91, s55, 15360
    s_cselect_b32 s92, 1024, 0
    s_mov_b32 s3, 1
    s_add_u32 s73, s72, 24576
    s_sub_u32 s66, s73, 86016
    s_cselect_b32 s73, s73, s66
    s_add_u32 s74, s73, 24576
    s_sub_u32 s66, s74, 86016
    s_cselect_b32 s74, s74, s66
    s_add_u32 s75, s74, 24576
    s_sub_u32 s66, s75, 86016
    s_cselect_b32 s75, s75, s66
    s_add_u32 s76, s75, 24576
    s_sub_u32 s66, s76, 86016
    s_cselect_b32 s76, s76, s66
    s_add_u32 s77, s76, 24576
    s_sub_u32 s66, s77, 86016
    s_cselect_b32 s77, s77, s66
    s_add_u32 s78, s77, 24576
    s_sub_u32 s66, s78, 86016
    s_cselect_b32 s78, s78, s66
    s_add_u32 s79, s78, 24576
    s_sub_u32 s66, s79, 86016
    s_cselect_b32 s79, s79, s66
    s_add_u32 s80, s79, 24576
    s_sub_u32 s66, s80, 86016
    s_cselect_b32 s80, s80, s66
    s_add_u32 s81, s80, 24576
    s_sub_u32 s66, s81, 86016
    s_cselect_b32 s81, s81, s66
    s_add_u32 s82, s81, 24576
    s_sub_u32 s66, s82, 86016
    s_cselect_b32 s82, s82, s66
    s_add_u32 s84, s83, 8192
    s_and_b32 s84, s84, 0x7fff
    s_add_u32 s85, s84, 8192
    s_and_b32 s85, s85, 0x7fff
    s_add_u32 s86, s85, 8192
    s_and_b32 s86, s86, 0x7fff
    s_lshl_b32 s69, s69, 12
    s_add_u32 s75, s75, s69
    s_add_u32 s76, s76, 4096
    s_add_u32 s77, s77, 4096
    s_add_u32 s78, s78, 4096
    s_add_u32 s79, s79, 8192
    s_add_u32 s80, s80, 8192
    s_add_u32 s81, s81, 8192
    s_add_u32 s82, s82, 8192
    s_add_u32 s83, s83, 90112
    s_add_u32 s84, s84, 90112
    s_add_u32 s85, s85, 90112
    s_add_u32 s86, s86, 90112
    s_cmp_ge_u32 s49, 2
    s_cselect_b32 s82, 86016, s82
    s_cmp_eq_u32 s49, 3
    s_cselect_b32 s82, 0x7f200000, s82
    v_lshrrev_b32 v245, 1, v242
    v_xor_b32 v245, v245, v243
    v_lshlrev_b32 v245, 4, v245
    v_lshl_add_u32 v245, v242, 7, v245
    v_add_u32 v15, s55, v245
    v_xor_b32 v16, 64, v15
    v_bfe_u32 v245, v1, 2, 2
    v_lshl_add_u32 v245, v243, 3, v245
    v_lshl_add_u32 v245, v245, 7, v244
    v_xor_b32 v17, 0, v245
    v_add_u32 v17, 0x18000, v17
    v_xor_b32 v18, 32, v17
    v_xor_b32 v19, 64, v17
    v_xor_b32 v20, 0x60, v17
    v_lshlrev_b32 v245, 3, v243
    s_mul_i32 s66, s51, 384
    s_cmp_eq_u32 s52, 1
    s_cselect_b32 s66, s66, 0x7f000000
    v_add_u32 v163, s66, v245
    s_lshl2_add_u32 s66, s50, s49
    s_lshr_b32 s70, s66, 3
    s_sub_u32 s70, s66, s70
    s_mul_i32 s70, s70, 122880
    s_and_b32 s88, s66, 7
    s_lshl_b32 s88, s88, 9
    s_add_u32 s88, s88, 7864320
    s_sub_u32 s88, s88, s70
    s_mul_i32 s87, s66, 122880
    s_lshl_b32 s93, s66, 8
    s_add_u32 s93, s93, 9437184
    s_mul_i32 s66, s51, 12288
    s_add_u32 s66, s66, 8192
    s_mul_i32 s67, s51, 4096
    s_add_u32 s67, s67, 90112
    s_cmp_eq_u32 s52, 1
    s_cselect_b32 s66, s66, s67
    s_add_u32 s87, s87, s66
    s_cmp_eq_u32 s59, 1
    s_cselect_b32 s87, 0x7f000000, s87
    s_cmp_eq_u32 s52, 1
    s_cselect_b32 s63, 0, 0x358637bd
    s_add_u32 m0, s55, 32768
    s_add_u32 s66, s53, 1
    s_and_b32 s66, s66, 7
    s_lshl_b32 s67, s66, 7
    s_mul_i32 s68, s66, s54
    buffer_load_dwordx4 v3, s[8:11], s67 offen lds
    s_add_u32 m0, s56, 49152
    s_nop 0
    buffer_load_dwordx4 v7, s[12:15], s68 offen lds
    s_add_u32 m0, s55, 33792
    s_nop 0
    buffer_load_dwordx4 v4, s[8:11], s67 offen lds
    s_add_u32 m0, s56, 50176
    s_nop 0
    buffer_load_dwordx4 v8, s[12:15], s68 offen lds
    s_add_u32 m0, s55, 34816
    s_nop 0
    buffer_load_dwordx4 v5, s[8:11], s67 offen lds
    s_add_u32 m0, s56, 57344
    s_nop 0
    buffer_load_dwordx4 v9, s[12:15], s68 offen lds
    s_add_u32 m0, s55, 35840
    s_nop 0
    buffer_load_dwordx4 v6, s[8:11], s67 offen lds
    s_add_u32 m0, s56, 58368
    s_nop 0
    buffer_load_dwordx4 v10, s[12:15], s68 offen lds
    s_waitcnt lgkmcnt(0)
    buffer_load_dwordx2 v[160:161], v163, s[16:19], 0 offen offset:256
    buffer_load_dwordx2 v[164:165], v163, s[16:19], 0 offen offset:288
    buffer_load_dwordx2 v[168:169], v163, s[16:19], 0 offen offset:320
    buffer_load_dwordx2 v[172:173], v163, s[16:19], 0 offen offset:352
    buffer_load_dwordx2 v[30:31], v28, s[44:47], 0 offen offset:32
    buffer_load_dwordx2 v[28:29], v28, s[44:47], 0 offen
    s_mul_i32 s69, s2, 5504
    s_mul_i32 s71, s49, 1408
    s_min_u32 s71, s71, 4096
    s_add_u32 s69, s69, s71
    s_lshl2_add_u32 s71, s2, s49
    s_lshl_b32 s71, s71, 9
    s_buffer_load_dwordx2 s[0:1], s[32:35], s69 offset:60
    s_buffer_load_dwordx2 s[0:1], s[32:35], s69 offset:188
    s_buffer_load_dwordx2 s[0:1], s[32:35], s69 offset:316
    s_buffer_load_dwordx2 s[0:1], s[32:35], s69 offset:444
    s_buffer_load_dwordx2 s[0:1], s[32:35], s69 offset:572
    s_waitcnt vmcnt(14)
    s_barrier
    s_add_u32 m0, s55, 65536
    s_add_u32 s66, s53, 2
    s_and_b32 s66, s66, 7
    s_lshl_b32 s67, s66, 7
    s_mul_i32 s68, s66, s54
    buffer_load_dwordx4 v3, s[8:11], s67 offen lds
    s_add_u32 m0, s56, 81920
    s_nop 0
    buffer_load_dwordx4 v7, s[12:15], s68 offen lds
    s_add_u32 m0, s55, 66560
    s_nop 0
    buffer_load_dwordx4 v4, s[8:11], s67 offen lds
    s_add_u32 m0, s56, 82944
    s_nop 0
    buffer_load_dwordx4 v8, s[12:15], s68 offen lds
    s_add_u32 m0, s55, 67584
    s_nop 0
    buffer_load_dwordx4 v5, s[8:11], s67 offen lds
    s_add_u32 m0, s56, 90112
    s_nop 0
    buffer_load_dwordx4 v9, s[12:15], s68 offen lds
    s_add_u32 m0, s55, 68608
    s_nop 0
    buffer_load_dwordx4 v6, s[8:11], s67 offen lds
    s_add_u32 m0, s56, 91136
    s_nop 0
    buffer_load_dwordx4 v10, s[12:15], s68 offen lds
    s_add_u32 m0, s55, 98304
    s_add_u32 s66, s53, 3
    s_and_b32 s66, s66, 7
    s_lshl_b32 s67, s66, 7
    s_mul_i32 s68, s66, s54
    buffer_load_dwordx4 v3, s[8:11], s67 offen lds
    s_add_u32 m0, s56, 114688
    s_nop 0
    buffer_load_dwordx4 v7, s[12:15], s68 offen lds
    ds_read_b128 v[32:35], v15 offset:0
    ds_read_b128 v[36:39], v15 offset:2048
    ds_read_b128 v[40:43], v16 offset:0
    ds_read_b128 v[44:47], v16 offset:2048
    s_waitcnt vmcnt(16)
    s_barrier
    s_buffer_load_dwordx2 s[0:1], s[32:35], s69 offset:700
    s_buffer_load_dwordx2 s[0:1], s[32:35], s69 offset:828
    s_buffer_load_dwordx2 s[0:1], s[32:35], s69 offset:956
    s_buffer_load_dwordx2 s[0:1], s[32:35], s69 offset:1084
    s_add_u32 m0, s55, 99328
    s_nop 0
    buffer_load_dwordx4 v4, s[8:11], s67 offen lds
    s_add_u32 m0, s56, 115712
    s_nop 0
    buffer_load_dwordx4 v8, s[12:15], s68 offen lds
    s_add_u32 m0, s55, 100352
    s_nop 0
    buffer_load_dwordx4 v5, s[8:11], s67 offen lds
    s_add_u32 m0, s56, 122880
    s_nop 0
    buffer_load_dwordx4 v9, s[12:15], s68 offen lds
    s_add_u32 m0, s55, 101376
    s_nop 0
    buffer_load_dwordx4 v6, s[8:11], s67 offen lds
    s_add_u32 m0, s56, 123904
    s_nop 0
    buffer_load_dwordx4 v10, s[12:15], s68 offen lds
    s_add_u32 m0, s55, 131072
    s_add_u32 s66, s53, 4
    s_and_b32 s66, s66, 7
    s_lshl_b32 s67, s66, 7
    s_mul_i32 s68, s66, s54
    buffer_load_dwordx4 v3, s[8:11], s67 offen lds
    s_add_u32 m0, s56, 147456
    s_nop 0
    buffer_load_dwordx4 v7, s[12:15], s68 offen lds
    s_add_u32 m0, s55, 132096
    s_nop 0
    buffer_load_dwordx4 v4, s[8:11], s67 offen lds
    s_add_u32 m0, s56, 148480
    s_nop 0
    buffer_load_dwordx4 v8, s[12:15], s68 offen lds
    ds_read_b128 v[48:51], v15 offset:32768
    ds_read_b128 v[52:55], v15 offset:34816
    ds_read_b128 v[56:59], v16 offset:32768
    ds_read_b128 v[60:63], v16 offset:34816
    s_cmp_eq_u32 s59, 0
    s_cbranch_scc1 L_ng0
    s_waitcnt lgkmcnt(4)
    v_mfma_f32_16x16x32_bf16 v[248:251], v[176:179], v[32:35], 0
    v_mfma_f32_16x16x32_bf16 v[252:255], v[176:179], v[36:39], 0
    v_mfma_f32_16x16x32_bf16 v[248:251], v[180:183], v[40:43], v[248:251]
    v_mfma_f32_16x16x32_bf16 v[252:255], v[180:183], v[44:47], v[252:255]
    s_nop 7
L_ng0:
    s_waitcnt vmcnt(12)
    s_waitcnt lgkmcnt(4)
    s_barrier
    v_add_u32 v15, 0x10000, v15
    v_add_u32 v16, 0x10000, v16
    s_buffer_load_dwordx2 s[0:1], s[32:35], s69 offset:1212
    s_buffer_load_dwordx2 s[0:1], s[32:35], s69 offset:1340
    v_and_b32 v163, 0xffff0000, v161
    s_add_u32 m0, s55, 133120
    v_lshlrev_b32 v162, 16, v161
    buffer_load_dwordx4 v5, s[8:11], s67 offen lds
    v_and_b32 v161, 0xffff0000, v160
    s_add_u32 m0, s56, 155648
    v_lshlrev_b32 v160, 16, v160
    buffer_load_dwordx4 v9, s[12:15], s68 offen lds
    s_add_u32 m0, s55, 134144
    v_and_b32 v167, 0xffff0000, v165
    buffer_load_dwordx4 v6, s[8:11], s67 offen lds
    v_lshlrev_b32 v166, 16, v165
    s_add_u32 m0, s56, 156672
    v_and_b32 v165, 0xffff0000, v164
    buffer_load_dwordx4 v10, s[12:15], s68 offen lds
    v_lshlrev_b32 v164, 16, v164
    s_add_u32 m0, s55, 0
    s_add_u32 s66, s53, 5
    s_and_b32 s66, s66, 7
    s_lshl_b32 s67, s66, 7
    s_mul_i32 s68, s66, s54
    buffer_load_dwordx4 v3, s[8:11], s67 offen lds
    v_and_b32 v171, 0xffff0000, v169
    s_add_u32 m0, s56, 16384
    v_lshlrev_b32 v170, 16, v169
    buffer_load_dwordx4 v7, s[12:15], s68 offen lds
    v_and_b32 v169, 0xffff0000, v168
    s_add_u32 m0, s55, 1024
    v_lshlrev_b32 v168, 16, v168
    buffer_load_dwordx4 v4, s[8:11], s67 offen lds
    s_add_u32 m0, s56, 17408
    v_and_b32 v175, 0xffff0000, v173
    buffer_load_dwordx4 v8, s[12:15], s68 offen lds
    v_lshlrev_b32 v174, 16, v173
    s_add_u32 m0, s55, 2048
    v_and_b32 v173, 0xffff0000, v172
    buffer_load_dwordx4 v5, s[8:11], s67 offen lds
    v_lshlrev_b32 v172, 16, v172
    s_add_u32 m0, s56, 24576
    s_nop 0
    buffer_load_dwordx4 v9, s[12:15], s68 offen lds
    ds_read_b128 v[64:67], v15 offset:0
    ds_read_b128 v[68:71], v15 offset:2048
    ds_read_b128 v[72:75], v16 offset:0
    ds_read_b128 v[76:79], v16 offset:2048
    s_cmp_eq_u32 s59, 0
    s_cbranch_scc1 L_ng1
    s_waitcnt lgkmcnt(4)
    v_mfma_f32_16x16x32_bf16 v[248:251], v[184:187], v[48:51], v[248:251]
    v_mfma_f32_16x16x32_bf16 v[252:255], v[184:187], v[52:55], v[252:255]
    v_mfma_f32_16x16x32_bf16 v[248:251], v[188:191], v[56:59], v[248:251]
    v_mfma_f32_16x16x32_bf16 v[252:255], v[188:191], v[60:63], v[252:255]
    s_nop 7
L_ng1:
    s_waitcnt vmcnt(14)
    s_waitcnt lgkmcnt(4)
    s_barrier
    buffer_load_dword v247, off, s[28:31], 0 sc1
    s_buffer_load_dwordx2 s[0:1], s[36:39], s71 offset:60
    s_buffer_load_dwordx2 s[0:1], s[36:39], s71 offset:188
    v_add_f32 v160, s63, v160
    s_add_u32 m0, s55, 3072
    v_add_f32 v161, s63, v161
    buffer_load_dwordx4 v6, s[8:11], s67 offen lds
    v_add_f32 v162, s63, v162
    s_add_u32 m0, s56, 25600
    v_add_f32 v163, s63, v163
    buffer_load_dwordx4 v10, s[12:15], s68 offen lds
    s_add_u32 m0, s55, 32768
    s_add_u32 s66, s53, 6
    s_and_b32 s66, s66, 7
    s_lshl_b32 s67, s66, 7
    s_mul_i32 s68, s66, s54
    v_add_f32 v164, s63, v164
    buffer_load_dwordx4 v3, s[8:11], s67 offen lds
    v_add_f32 v165, s63, v165
    s_add_u32 m0, s56, 49152
    v_add_f32 v166, s63, v166
    buffer_load_dwordx4 v7, s[12:15], s68 offen lds
    v_add_f32 v167, s63, v167
    s_add_u32 m0, s55, 33792
    s_nop 0
    buffer_load_dwordx4 v4, s[8:11], s67 offen lds
    v_add_f32 v168, s63, v168
    s_add_u32 m0, s56, 50176
    v_add_f32 v169, s63, v169
    buffer_load_dwordx4 v8, s[12:15], s68 offen lds
    v_add_f32 v170, s63, v170
    s_add_u32 m0, s55, 34816
    v_add_f32 v171, s63, v171
    buffer_load_dwordx4 v5, s[8:11], s67 offen lds
    s_add_u32 m0, s56, 57344
    v_add_f32 v172, s63, v172
    buffer_load_dwordx4 v9, s[12:15], s68 offen lds
    v_add_f32 v173, s63, v173
    s_add_u32 m0, s55, 35840
    v_add_f32 v174, s63, v174
    buffer_load_dwordx4 v6, s[8:11], s67 offen lds
    v_add_f32 v175, s63, v175
    s_add_u32 m0, s56, 58368
    s_nop 0
    buffer_load_dwordx4 v10, s[12:15], s68 offen lds
    ds_read_b128 v[80:83], v15 offset:32768
    ds_read_b128 v[84:87], v15 offset:34816
    ds_read_b128 v[88:91], v16 offset:32768
    ds_read_b128 v[92:95], v16 offset:34816
    s_cmp_eq_u32 s59, 0
    s_cbranch_scc1 L_ng2
    s_waitcnt lgkmcnt(4)
    v_mfma_f32_16x16x32_bf16 v[248:251], v[192:195], v[64:67], v[248:251]
    v_mfma_f32_16x16x32_bf16 v[252:255], v[192:195], v[68:71], v[252:255]
    v_mfma_f32_16x16x32_bf16 v[248:251], v[196:199], v[72:75], v[248:251]
    v_mfma_f32_16x16x32_bf16 v[252:255], v[196:199], v[76:79], v[252:255]
    s_nop 7
L_ng2:
    s_waitcnt vmcnt(17)
    s_waitcnt lgkmcnt(4)
    s_barrier
    v_add_u32 v15, 0x10000, v15
    v_add_u32 v16, 0x10000, v16
    s_buffer_load_dwordx2 s[0:1], s[36:39], s71 offset:316
    s_buffer_load_dwordx2 s[0:1], s[36:39], s71 offset:444
    s_add_u32 m0, s55, 65536
    s_add_u32 s66, s53, 7
    s_and_b32 s66, s66, 7
    s_lshl_b32 s67, s66, 7
    s_mul_i32 s68, s66, s54
    buffer_load_dwordx4 v3, s[8:11], s67 offen lds
    s_add_u32 m0, s56, 81920
    s_nop 0
    buffer_load_dwordx4 v7, s[12:15], s68 offen lds
    s_add_u32 m0, s55, 66560
    s_nop 0
    buffer_load_dwordx4 v4, s[8:11], s67 offen lds
    s_add_u32 m0, s56, 82944
    s_nop 0
    buffer_load_dwordx4 v8, s[12:15], s68 offen lds
    s_add_u32 m0, s55, 67584
    s_nop 0
    buffer_load_dwordx4 v5, s[8:11], s67 offen lds
    s_add_u32 m0, s56, 90112
    s_nop 0
    buffer_load_dwordx4 v9, s[12:15], s68 offen lds
    s_add_u32 m0, s55, 68608
    s_nop 0
    buffer_load_dwordx4 v6, s[8:11], s67 offen lds
    s_add_u32 m0, s56, 91136
    s_nop 0
    buffer_load_dwordx4 v10, s[12:15], s68 offen lds
    ds_read_b128 v[96:99], v15 offset:0
    ds_read_b128 v[100:103], v15 offset:2048
    ds_read_b128 v[104:107], v16 offset:0
    ds_read_b128 v[108:111], v16 offset:2048
    s_cmp_eq_u32 s59, 0
    s_cbranch_scc1 L_ng3
    s_waitcnt lgkmcnt(4)
    v_mfma_f32_16x16x32_bf16 v[248:251], v[200:203], v[80:83], v[248:251]
    v_mfma_f32_16x16x32_bf16 v[252:255], v[200:203], v[84:87], v[252:255]
    v_mfma_f32_16x16x32_bf16 v[248:251], v[204:207], v[88:91], v[248:251]
    v_mfma_f32_16x16x32_bf16 v[252:255], v[204:207], v[92:95], v[252:255]
    s_nop 7
L_ng3:
    s_waitcnt vmcnt(16)
    s_waitcnt lgkmcnt(4)
    s_barrier
    v_add_u32 v15, 0xfffe0000, v15
    v_add_u32 v16, 0xfffe0000, v16
    s_add_u32 m0, s56, 98304
    s_add_u32 s66, s53, 0
    s_and_b32 s66, s66, 7
    s_mul_i32 s68, s66, s54
    buffer_load_dwordx4 v11, s[12:15], s68 offen lds
    s_add_u32 m0, s56, 99328
    s_nop 0
    buffer_load_dwordx4 v12, s[12:15], s68 offen lds
    s_add_u32 m0, s56, 106496
    s_add_u32 s66, s53, 1
    s_and_b32 s66, s66, 7
    s_mul_i32 s68, s66, s54
    buffer_load_dwordx4 v11, s[12:15], s68 offen lds
    s_add_u32 m0, s56, 107520
    s_nop 0
    buffer_load_dwordx4 v12, s[12:15], s68 offen lds
    s_add_u32 m0, s56, 114688
    s_add_u32 s66, s53, 2
    s_and_b32 s66, s66, 7
    s_mul_i32 s68, s66, s54
    buffer_load_dwordx4 v11, s[12:15], s68 offen lds
    s_add_u32 m0, s56, 115712
    s_nop 0
    buffer_load_dwordx4 v12, s[12:15], s68 offen lds
    s_add_u32 m0, s56, 122880
    s_add_u32 s66, s53, 3
    s_and_b32 s66, s66, 7
    s_mul_i32 s68, s66, s54
    buffer_load_dwordx4 v11, s[12:15], s68 offen lds
    s_add_u32 m0, s56, 123904
    s_nop 0
    buffer_load_dwordx4 v12, s[12:15], s68 offen lds
    ds_read_b128 v[112:115], v15 offset:0
    ds_read_b128 v[116:119], v15 offset:2048
    ds_read_b128 v[120:123], v16 offset:0
    ds_read_b128 v[124:127], v16 offset:2048
    s_cmp_eq_u32 s59, 0
    s_cbranch_scc1 L_ng4
    s_waitcnt lgkmcnt(4)
    v_mfma_f32_16x16x32_bf16 v[248:251], v[208:211], v[96:99], v[248:251]
    v_mfma_f32_16x16x32_bf16 v[252:255], v[208:211], v[100:103], v[252:255]
    v_mfma_f32_16x16x32_bf16 v[248:251], v[212:215], v[104:107], v[248:251]
    v_mfma_f32_16x16x32_bf16 v[252:255], v[212:215], v[108:111], v[252:255]
    s_nop 7
L_ng4:
    s_waitcnt vmcnt(16)
    s_waitcnt lgkmcnt(4)
    s_barrier
    s_add_u32 m0, s56, 131072
    s_add_u32 s66, s53, 4
    s_and_b32 s66, s66, 7
    s_mul_i32 s68, s66, s54
    buffer_load_dwordx4 v11, s[12:15], s68 offen lds
    s_add_u32 m0, s56, 132096
    s_nop 0
    buffer_load_dwordx4 v12, s[12:15], s68 offen lds
    s_add_u32 m0, s56, 139264
    s_add_u32 s66, s53, 5
    s_and_b32 s66, s66, 7
    s_mul_i32 s68, s66, s54
    buffer_load_dwordx4 v11, s[12:15], s68 offen lds
    s_add_u32 m0, s56, 140288
    s_nop 0
    buffer_load_dwordx4 v12, s[12:15], s68 offen lds
    s_add_u32 m0, s56, 147456
    s_add_u32 s66, s53, 6
    s_and_b32 s66, s66, 7
    s_mul_i32 s68, s66, s54
    buffer_load_dwordx4 v11, s[12:15], s68 offen lds
    s_add_u32 m0, s56, 148480
    s_nop 0
    buffer_load_dwordx4 v12, s[12:15], s68 offen lds
    s_add_u32 m0, s56, 155648
    s_add_u32 s66, s53, 7
    s_and_b32 s66, s66, 7
    s_mul_i32 s68, s66, s54
    buffer_load_dwordx4 v11, s[12:15], s68 offen lds
    s_add_u32 m0, s56, 156672
    s_nop 0
    buffer_load_dwordx4 v12, s[12:15], s68 offen lds
    ds_read_b128 v[128:131], v15 offset:32768
    ds_read_b128 v[132:135], v15 offset:34816
    ds_read_b128 v[136:139], v16 offset:32768
    ds_read_b128 v[140:143], v16 offset:34816
    s_cmp_eq_u32 s59, 0
    s_cbranch_scc1 L_ng5
    s_waitcnt lgkmcnt(4)
    v_mfma_f32_16x16x32_bf16 v[248:251], v[216:219], v[112:115], v[248:251]
    v_mfma_f32_16x16x32_bf16 v[252:255], v[216:219], v[116:119], v[252:255]
    v_mfma_f32_16x16x32_bf16 v[248:251], v[220:223], v[120:123], v[248:251]
    v_mfma_f32_16x16x32_bf16 v[252:255], v[220:223], v[124:127], v[252:255]
    s_nop 7
L_ng5:
    v_cmp_eq_u32 vcc, 0, v247
    s_cbranch_vccnz L_slow1
L_back1:
    v_readfirstlane_b32 s61, v247
    s_cmp_eq_u32 s49, 3
    s_cselect_b32 s23, 0, s61
    s_lshl_b32 s62, s61, 1
    s_waitcnt vmcnt(8)
    s_waitcnt lgkmcnt(4)
    s_barrier
    v_add_u32 v15, 0x10000, v15
    v_add_u32 v16, 0x10000, v16
    s_add_u32 m0, s55, 0
    s_lshl4_add_u32 s70, s72, 0
    buffer_load_dwordx4 v13, s[32:35], s70 offen lds
    s_add_u32 m0, s55, 1024
    s_nop 0
    buffer_load_dwordx4 v14, s[32:35], s70 offen lds
    s_add_u32 m0, s55, 2048
    s_add_u32 s70, s70, 0x4000
    buffer_load_dwordx4 v13, s[32:35], s70 offen lds
    s_add_u32 m0, s55, 3072
    s_nop 0
    buffer_load_dwordx4 v14, s[32:35], s70 offen lds
    s_add_u32 m0, s55, 16384
    s_lshl4_add_u32 s70, s73, 0
    buffer_load_dwordx4 v13, s[32:35], s70 offen lds
    s_add_u32 m0, s55, 17408
    s_nop 0
    buffer_load_dwordx4 v14, s[32:35], s70 offen lds
    s_add_u32 m0, s55, 18432
    s_add_u32 s70, s70, 0x4000
    buffer_load_dwordx4 v13, s[32:35], s70 offen lds
    s_add_u32 m0, s55, 19456
    s_nop 0
    buffer_load_dwordx4 v14, s[32:35], s70 offen lds
    ds_read_b128 v[144:147], v15 offset:0
    ds_read_b128 v[148:151], v15 offset:2048
    ds_read_b128 v[152:155], v16 offset:0
    ds_read_b128 v[156:159], v16 offset:2048
    s_cmp_eq_u32 s59, 0
    s_cbranch_scc1 L_ng6
    s_waitcnt lgkmcnt(4)
    v_mfma_f32_16x16x32_bf16 v[248:251], v[224:227], v[128:131], v[248:251]
    v_mfma_f32_16x16x32_bf16 v[252:255], v[224:227], v[132:135], v[252:255]
    v_mfma_f32_16x16x32_bf16 v[248:251], v[228:231], v[136:139], v[248:251]
    v_mfma_f32_16x16x32_bf16 v[252:255], v[228:231], v[140:143], v[252:255]
    s_nop 7
L_ng6:
    s_cmp_eq_u32 s59, 0
    s_cbranch_scc1 L_ng7
    s_waitcnt lgkmcnt(0)
    v_mfma_f32_16x16x32_bf16 v[248:251], v[232:235], v[144:147], v[248:251]
    v_mfma_f32_16x16x32_bf16 v[252:255], v[232:235], v[148:151], v[252:255]
    v_mfma_f32_16x16x32_bf16 v[248:251], v[236:239], v[152:155], v[248:251]
    v_mfma_f32_16x16x32_bf16 v[252:255], v[236:239], v[156:159], v[252:255]
    s_nop 7
L_ng7:
    s_cmp_eq_u32 s59, 0
    s_cbranch_scc1 L_nogate
    v_cmp_gt_u32 vcc, 16, v1
    s_nop 1
    v_cndmask_b32 v240, v252, v248, vcc
    v_mul_f32 v240, 0xbfb8aa3b, v240
    v_exp_f32 v240, v240
    v_lshlrev_b32 v242, 3, v1
    v_add_f32 v240, 1.0, v240
    v_mov_b32 v241, s61
    v_rcp_f32 v240, v240
    s_mov_b32 exec_hi, 0
    buffer_store_dwordx2 v[240:241], v242, s[24:27], s93 offen sc1
    s_mov_b32 exec_hi, -1
    s_nop 7
L_nogate:
    s_waitcnt lgkmcnt(0)
    ds_read_b64_tr_b16 v[208:209], v17 offset:0
    ds_read_b64_tr_b16 v[210:211], v17 offset:512
    ds_read_b64_tr_b16 v[212:213], v18 offset:0
    ds_read_b64_tr_b16 v[214:215], v18 offset:512
    ds_read_b64_tr_b16 v[216:217], v19 offset:0
    ds_read_b64_tr_b16 v[218:219], v19 offset:512
    ds_read_b64_tr_b16 v[220:221], v20 offset:0
    ds_read_b64_tr_b16 v[222:223], v20 offset:512
    ds_read_b64_tr_b16 v[224:225], v17 offset:4096
    ds_read_b64_tr_b16 v[226:227], v17 offset:4608
    ds_read_b64_tr_b16 v[228:229], v18 offset:4096
    ds_read_b64_tr_b16 v[230:231], v18 offset:4608
    ds_read_b64_tr_b16 v[232:233], v19 offset:4096
    ds_read_b64_tr_b16 v[234:235], v19 offset:4608
    ds_read_b64_tr_b16 v[236:237], v20 offset:4096
    ds_read_b64_tr_b16 v[238:239], v20 offset:4608
    v_lshl_add_u32 v12, v1, 2, s88
    s_barrier
    s_setprio 1
    s_waitcnt lgkmcnt(8)
    v_mfma_f32_16x16x32_bf16 v[176:179], v[208:211], v[32:35], v[160:163]
    ds_read_b64_tr_b16 v[240:241], v17 offset:8192
    s_add_u32 m0, s55, 32768
    s_lshl4_add_u32 s70, s74, 0
    v_mfma_f32_16x16x32_bf16 v[184:187], v[208:211], v[36:39], v[160:163]
    ds_read_b64_tr_b16 v[242:243], v17 offset:8704
    v_mfma_f32_16x16x32_bf16 v[180:183], v[212:215], v[32:35], v[164:167]
    ds_read_b64_tr_b16 v[244:245], v18 offset:8192
    buffer_load_dwordx4 v13, s[32:35], s70 offen lds
    v_mfma_f32_16x16x32_bf16 v[188:191], v[212:215], v[36:39], v[164:167]
    ds_read_b64_tr_b16 v[246:247], v18 offset:8704
    v_mfma_f32_16x16x32_bf16 v[192:195], v[216:219], v[32:35], v[168:171]
    ds_read_b64_tr_b16 v[248:249], v19 offset:8192
    s_add_u32 m0, s55, 33792
    v_mfma_f32_16x16x32_bf16 v[200:203], v[216:219], v[36:39], v[168:171]
    ds_read_b64_tr_b16 v[250:251], v19 offset:8704
    v_mfma_f32_16x16x32_bf16 v[196:199], v[220:223], v[32:35], v[172:175]
    ds_read_b64_tr_b16 v[252:253], v20 offset:8192
    buffer_load_dwordx4 v14, s[32:35], s70 offen lds
    v_mfma_f32_16x16x32_bf16 v[204:207], v[220:223], v[36:39], v[172:175]
    ds_read_b64_tr_b16 v[254:255], v20 offset:8704
    s_waitcnt lgkmcnt(8)
    v_mfma_f32_16x16x32_bf16 v[176:179], v[224:227], v[40:43], v[176:179]
    ds_read_b64_tr_b16 v[208:209], v17 offset:12288
    s_add_u32 m0, s55, 34816
    s_add_u32 s70, s70, 0x4000
    v_mfma_f32_16x16x32_bf16 v[184:187], v[224:227], v[44:47], v[184:187]
    ds_read_b64_tr_b16 v[210:211], v17 offset:12800
    v_mfma_f32_16x16x32_bf16 v[180:183], v[228:231], v[40:43], v[180:183]
    ds_read_b64_tr_b16 v[212:213], v18 offset:12288
    buffer_load_dwordx4 v13, s[32:35], s70 offen lds
    v_mfma_f32_16x16x32_bf16 v[188:191], v[228:231], v[44:47], v[188:191]
    ds_read_b64_tr_b16 v[214:215], v18 offset:12800
    v_mfma_f32_16x16x32_bf16 v[192:195], v[232:235], v[40:43], v[192:195]
    ds_read_b64_tr_b16 v[216:217], v19 offset:12288
    s_add_u32 m0, s55, 35840
    v_mfma_f32_16x16x32_bf16 v[200:203], v[232:235], v[44:47], v[200:203]
    ds_read_b64_tr_b16 v[218:219], v19 offset:12800
    v_mfma_f32_16x16x32_bf16 v[196:199], v[236:239], v[40:43], v[196:199]
    ds_read_b64_tr_b16 v[220:221], v20 offset:12288
    buffer_load_dwordx4 v14, s[32:35], s70 offen lds
    v_mfma_f32_16x16x32_bf16 v[204:207], v[236:239], v[44:47], v[204:207]
    ds_read_b64_tr_b16 v[222:223], v20 offset:12800
    s_waitcnt lgkmcnt(8)
    v_mfma_f32_16x16x32_bf16 v[176:179], v[240:243], v[48:51], v[176:179]
    ds_read_b64_tr_b16 v[224:225], v17 offset:16384
    s_add_u32 m0, s55, 49152
    s_lshl4_add_u32 s70, s75, 0
    v_mfma_f32_16x16x32_bf16 v[184:187], v[240:243], v[52:55], v[184:187]
    ds_read_b64_tr_b16 v[226:227], v17 offset:16896
    v_mfma_f32_16x16x32_bf16 v[180:183], v[244:247], v[48:51], v[180:183]
    ds_read_b64_tr_b16 v[228:229], v18 offset:16384
    buffer_load_dwordx4 v13, s[32:35], s70 offen lds
    v_mfma_f32_16x16x32_bf16 v[188:191], v[244:247], v[52:55], v[188:191]
    ds_read_b64_tr_b16 v[230:231], v18 offset:16896
    v_mfma_f32_16x16x32_bf16 v[192:195], v[248:251], v[48:51], v[192:195]
    ds_read_b64_tr_b16 v[232:233], v19 offset:16384
    s_add_u32 m0, s55, 50176
    v_mfma_f32_16x16x32_bf16 v[200:203], v[248:251], v[52:55], v[200:203]
    ds_read_b64_tr_b16 v[234:235], v19 offset:16896
    v_mfma_f32_16x16x32_bf16 v[196:199], v[252:255], v[48:51], v[196:199]
    ds_read_b64_tr_b16 v[236:237], v20 offset:16384
    buffer_load_dwordx4 v14, s[32:35], s70 offen lds
    v_mfma_f32_16x16x32_bf16 v[204:207], v[252:255], v[52:55], v[204:207]
    ds_read_b64_tr_b16 v[238:239], v20 offset:16896
    s_waitcnt lgkmcnt(8)
    v_mfma_f32_16x16x32_bf16 v[176:179], v[208:211], v[56:59], v[176:179]
    ds_read_b64_tr_b16 v[240:241], v17 offset:20480
    s_add_u32 m0, s55, 51200
    s_add_u32 s70, s70, 0x4000
    v_mfma_f32_16x16x32_bf16 v[184:187], v[208:211], v[60:63], v[184:187]
    ds_read_b64_tr_b16 v[242:243], v17 offset:20992
    v_mfma_f32_16x16x32_bf16 v[180:183], v[212:215], v[56:59], v[180:183]
    ds_read_b64_tr_b16 v[244:245], v18 offset:20480
    buffer_load_dwordx4 v13, s[32:35], s70 offen lds
    v_mfma_f32_16x16x32_bf16 v[188:191], v[212:215], v[60:63], v[188:191]
    ds_read_b64_tr_b16 v[246:247], v18 offset:20992
    v_mfma_f32_16x16x32_bf16 v[192:195], v[216:219], v[56:59], v[192:195]
    ds_read_b64_tr_b16 v[248:249], v19 offset:20480
    s_add_u32 m0, s55, 52224
    v_mfma_f32_16x16x32_bf16 v[200:203], v[216:219], v[60:63], v[200:203]
    ds_read_b64_tr_b16 v[250:251], v19 offset:20992
    v_mfma_f32_16x16x32_bf16 v[196:199], v[220:223], v[56:59], v[196:199]
    ds_read_b64_tr_b16 v[252:253], v20 offset:20480
    buffer_load_dwordx4 v14, s[32:35], s70 offen lds
    v_mfma_f32_16x16x32_bf16 v[204:207], v[220:223], v[60:63], v[204:207]
    ds_read_b64_tr_b16 v[254:255], v20 offset:20992
    s_waitcnt vmcnt(8)
    s_barrier
    s_waitcnt lgkmcnt(8)
    v_mfma_f32_16x16x32_bf16 v[176:179], v[224:227], v[64:67], v[176:179]
    ds_read_b64_tr_b16 v[208:209], v17 offset:24576
    s_add_u32 m0, s55, 65536
    s_lshl4_add_u32 s70, s76, 0
    buffer_load_dwordx4 v13, s[32:35], s70 offen lds
    v_mfma_f32_16x16x32_bf16 v[184:187], v[224:227], v[68:71], v[184:187]
    ds_read_b64_tr_b16 v[210:211], v17 offset:25088
    ds_read_b64_tr_b16 v[32:33], v21 offset:0
    v_mfma_f32_16x16x32_bf16 v[180:183], v[228:231], v[64:67], v[180:183]
    ds_read_b64_tr_b16 v[34:35], v21 offset:2048
    ds_read_b64_tr_b16 v[212:213], v18 offset:24576
    s_add_u32 m0, s55, 66560
    v_mfma_f32_16x16x32_bf16 v[188:191], v[228:231], v[68:71], v[188:191]
    ds_read_b64_tr_b16 v[214:215], v18 offset:25088
    ds_read_b64_tr_b16 v[36:37], v22 offset:0
    v_mfma_f32_16x16x32_bf16 v[192:195], v[232:235], v[64:67], v[192:195]
    ds_read_b64_tr_b16 v[216:217], v19 offset:24576
    buffer_load_dwordx4 v14, s[32:35], s70 offen lds
    s_add_u32 m0, s55, 67584
    s_add_u32 s70, s70, 0x4000
    v_mfma_f32_16x16x32_bf16 v[200:203], v[232:235], v[68:71], v[200:203]
    ds_read_b64_tr_b16 v[218:219], v19 offset:25088
    ds_read_b64_tr_b16 v[38:39], v22 offset:2048
    v_mfma_f32_16x16x32_bf16 v[196:199], v[236:239], v[64:67], v[196:199]
    ds_read_b64_tr_b16 v[40:41], v23 offset:0
    ds_read_b64_tr_b16 v[220:221], v20 offset:24576
    buffer_load_dwordx4 v13, s[32:35], s70 offen lds
    v_mfma_f32_16x16x32_bf16 v[204:207], v[236:239], v[68:71], v[204:207]
    ds_read_b64_tr_b16 v[222:223], v20 offset:25088
    ds_read_b64_tr_b16 v[42:43], v23 offset:2048
    s_waitcnt lgkmcnt(14)
    v_mfma_f32_16x16x32_bf16 v[176:179], v[240:243], v[72:75], v[176:179]
    ds_read_b64_tr_b16 v[224:225], v17 offset:28672
    s_add_u32 m0, s55, 68608
    s_nop 0
    buffer_load_dwordx4 v14, s[32:35], s70 offen lds
    v_mfma_f32_16x16x32_bf16 v[184:187], v[240:243], v[76:79], v[184:187]
    ds_read_b64_tr_b16 v[226:227], v17 offset:29184
    ds_read_b64_tr_b16 v[44:45], v24 offset:0
    v_mfma_f32_16x16x32_bf16 v[180:183], v[244:247], v[72:75], v[180:183]
    ds_read_b64_tr_b16 v[46:47], v24 offset:2048
    ds_read_b64_tr_b16 v[228:229], v18 offset:28672
    s_add_u32 m0, s55, 81920
    s_lshl4_add_u32 s70, s77, 0
    v_mfma_f32_16x16x32_bf16 v[188:191], v[244:247], v[76:79], v[188:191]
    ds_read_b64_tr_b16 v[230:231], v18 offset:29184
    ds_read_b64_tr_b16 v[48:49], v21 offset:16384
    v_mfma_f32_16x16x32_bf16 v[192:195], v[248:251], v[72:75], v[192:195]
    ds_read_b64_tr_b16 v[232:233], v19 offset:28672
    buffer_load_dwordx4 v13, s[32:35], s70 offen lds
    s_add_u32 m0, s55, 82944
    v_mfma_f32_16x16x32_bf16 v[200:203], v[248:251], v[76:79], v[200:203]
    ds_read_b64_tr_b16 v[234:235], v19 offset:29184
    ds_read_b64_tr_b16 v[50:51], v21 offset:18432
    v_mfma_f32_16x16x32_bf16 v[196:199], v[252:255], v[72:75], v[196:199]
    ds_read_b64_tr_b16 v[52:53], v22 offset:16384
    ds_read_b64_tr_b16 v[236:237], v20 offset:28672
    buffer_load_dwordx4 v14, s[32:35], s70 offen lds
    v_mfma_f32_16x16x32_bf16 v[204:207], v[252:255], v[76:79], v[204:207]
    ds_read_b64_tr_b16 v[238:239], v20 offset:29184
    ds_read_b64_tr_b16 v[54:55], v22 offset:18432
    s_waitcnt lgkmcnt(15)
    v_mfma_f32_16x16x32_bf16 v[176:179], v[208:211], v[80:83], v[176:179]
    ds_read_b64_tr_b16 v[240:241], v17 offset:32768
    s_add_u32 m0, s55, 83968
    s_add_u32 s70, s70, 0x4000
    buffer_load_dwordx4 v13, s[32:35], s70 offen lds
    v_mfma_f32_16x16x32_bf16 v[184:187], v[208:211], v[84:87], v[184:187]
    ds_read_b64_tr_b16 v[242:243], v17 offset:33280
    ds_read_b64_tr_b16 v[56:57], v23 offset:16384
    v_mfma_f32_16x16x32_bf16 v[180:183], v[212:215], v[80:83], v[180:183]
    ds_read_b64_tr_b16 v[244:245], v18 offset:32768
    s_add_u32 m0, s55, 84992
    v_mfma_f32_16x16x32_bf16 v[188:191], v[212:215], v[84:87], v[188:191]
    ds_read_b64_tr_b16 v[246:247], v18 offset:33280
    ds_read_b64_tr_b16 v[58:59], v23 offset:18432
    v_mfma_f32_16x16x32_bf16 v[192:195], v[216:219], v[80:83], v[192:195]
    ds_read_b64_tr_b16 v[248:249], v19 offset:32768
    buffer_load_dwordx4 v14, s[32:35], s70 offen lds
    s_add_u32 m0, s55, 98304
    s_lshl4_add_u32 s70, s78, 0
    v_mfma_f32_16x16x32_bf16 v[200:203], v[216:219], v[84:87], v[200:203]
    ds_read_b64_tr_b16 v[250:251], v19 offset:33280
    ds_read_b64_tr_b16 v[60:61], v24 offset:16384
    v_mfma_f32_16x16x32_bf16 v[196:199], v[220:223], v[80:83], v[196:199]
    ds_read_b64_tr_b16 v[252:253], v20 offset:32768
    buffer_load_dwordx4 v13, s[32:35], s70 offen lds
    v_mfma_f32_16x16x32_bf16 v[204:207], v[220:223], v[84:87], v[204:207]
    ds_read_b64_tr_b16 v[254:255], v20 offset:33280
    ds_read_b64_tr_b16 v[62:63], v24 offset:18432
    s_waitcnt lgkmcnt(13)
    v_mfma_f32_16x16x32_bf16 v[176:179], v[224:227], v[88:91], v[176:179]
    ds_read_b64_tr_b16 v[208:209], v17 offset:36864
    s_add_u32 m0, s55, 99328
    v_mfma_f32_16x16x32_bf16 v[184:187], v[224:227], v[92:95], v[184:187]
    buffer_load_dwordx4 v14, s[32:35], s70 offen lds
    ds_read_b64_tr_b16 v[210:211], v17 offset:37376
    v_mfma_f32_16x16x32_bf16 v[180:183], v[228:231], v[88:91], v[180:183]
    ds_read_b64_tr_b16 v[212:213], v18 offset:36864
    s_add_u32 m0, s55, 100352
    s_add_u32 s70, s70, 0x4000
    v_mfma_f32_16x16x32_bf16 v[188:191], v[228:231], v[92:95], v[188:191]
    ds_read_b64_tr_b16 v[214:215], v18 offset:37376
    v_mfma_f32_16x16x32_bf16 v[192:195], v[232:235], v[88:91], v[192:195]
    ds_read_b64_tr_b16 v[216:217], v19 offset:36864
    buffer_load_dwordx4 v13, s[32:35], s70 offen lds
    v_mfma_f32_16x16x32_bf16 v[200:203], v[232:235], v[92:95], v[200:203]
    s_add_u32 m0, s55, 101376
    ds_read_b64_tr_b16 v[218:219], v19 offset:37376
    v_mfma_f32_16x16x32_bf16 v[196:199], v[236:239], v[88:91], v[196:199]
    ds_read_b64_tr_b16 v[220:221], v20 offset:36864
    buffer_load_dwordx4 v14, s[32:35], s70 offen lds
    v_mfma_f32_16x16x32_bf16 v[204:207], v[236:239], v[92:95], v[204:207]
    ds_read_b64_tr_b16 v[222:223], v20 offset:37376
    s_waitcnt vmcnt(12)
    s_waitcnt lgkmcnt(8)
    s_barrier
    v_mfma_f32_16x16x32_bf16 v[176:179], v[240:243], v[96:99], v[176:179]
    ds_read_b64_tr_b16 v[224:225], v17 offset:40960
    s_add_u32 m0, s55, 114688
    s_lshl4_add_u32 s70, s79, 0
    buffer_load_dwordx4 v13, s[32:35], s70 offen lds
    v_mfma_f32_16x16x32_bf16 v[184:187], v[240:243], v[100:103], v[184:187]
    ds_read_b64_tr_b16 v[226:227], v17 offset:41472
    ds_read_b64_tr_b16 v[64:65], v21 offset:32768
    v_mfma_f32_16x16x32_bf16 v[180:183], v[244:247], v[96:99], v[180:183]
    ds_read_b64_tr_b16 v[66:67], v21 offset:34816
    ds_read_b64_tr_b16 v[228:229], v18 offset:40960
    s_add_u32 m0, s55, 115712
    v_mfma_f32_16x16x32_bf16 v[188:191], v[244:247], v[100:103], v[188:191]
    ds_read_b64_tr_b16 v[230:231], v18 offset:41472
    ds_read_b64_tr_b16 v[68:69], v22 offset:32768
    v_mfma_f32_16x16x32_bf16 v[192:195], v[248:251], v[96:99], v[192:195]
    ds_read_b64_tr_b16 v[232:233], v19 offset:40960
    buffer_load_dwordx4 v14, s[32:35], s70 offen lds
    s_add_u32 m0, s55, 116736
    s_add_u32 s70, s70, 0x4000
    v_mfma_f32_16x16x32_bf16 v[200:203], v[248:251], v[100:103], v[200:203]
    ds_read_b64_tr_b16 v[234:235], v19 offset:41472
    ds_read_b64_tr_b16 v[70:71], v22 offset:34816
    v_mfma_f32_16x16x32_bf16 v[196:199], v[252:255], v[96:99], v[196:199]
    ds_read_b64_tr_b16 v[72:73], v23 offset:32768
    ds_read_b64_tr_b16 v[236:237], v20 offset:40960
    buffer_load_dwordx4 v13, s[32:35], s70 offen lds
    v_mfma_f32_16x16x32_bf16 v[204:207], v[252:255], v[100:103], v[204:207]
    ds_read_b64_tr_b16 v[238:239], v20 offset:41472
    ds_read_b64_tr_b16 v[74:75], v23 offset:34816
    s_waitcnt lgkmcnt(14)
    v_mfma_f32_16x16x32_bf16 v[176:179], v[208:211], v[104:107], v[176:179]
    ds_read_b64_tr_b16 v[240:241], v17 offset:45056
    s_add_u32 m0, s55, 117760
    s_nop 0
    buffer_load_dwordx4 v14, s[32:35], s70 offen lds
    v_mfma_f32_16x16x32_bf16 v[184:187], v[208:211], v[108:111], v[184:187]
    ds_read_b64_tr_b16 v[242:243], v17 offset:45568
    ds_read_b64_tr_b16 v[76:77], v24 offset:32768
    v_mfma_f32_16x16x32_bf16 v[180:183], v[212:215], v[104:107], v[180:183]
    ds_read_b64_tr_b16 v[78:79], v24 offset:34816
    ds_read_b64_tr_b16 v[244:245], v18 offset:45056
    s_add_u32 m0, s55, 0
    s_lshl4_add_u32 s70, s80, 0
    v_mfma_f32_16x16x32_bf16 v[188:191], v[212:215], v[108:111], v[188:191]
    ds_read_b64_tr_b16 v[246:247], v18 offset:45568
    ds_read_b64_tr_b16 v[80:81], v21 offset:49152
    v_mfma_f32_16x16x32_bf16 v[192:195], v[216:219], v[104:107], v[192:195]
    ds_read_b64_tr_b16 v[248:249], v19 offset:45056
    buffer_load_dwordx4 v13, s[32:35], s70 offen lds
    s_add_u32 m0, s55, 1024
    v_mfma_f32_16x16x32_bf16 v[200:203], v[216:219], v[108:111], v[200:203]
    ds_read_b64_tr_b16 v[250:251], v19 offset:45568
    ds_read_b64_tr_b16 v[82:83], v21 offset:51200
    v_mfma_f32_16x16x32_bf16 v[196:199], v[220:223], v[104:107], v[196:199]
    ds_read_b64_tr_b16 v[84:85], v22 offset:49152
    ds_read_b64_tr_b16 v[252:253], v20 offset:45056
    buffer_load_dwordx4 v14, s[32:35], s70 offen lds
    v_mfma_f32_16x16x32_bf16 v[204:207], v[220:223], v[108:111], v[204:207]
    ds_read_b64_tr_b16 v[254:255], v20 offset:45568
    ds_read_b64_tr_b16 v[86:87], v22 offset:51200
    s_waitcnt lgkmcnt(15)
    v_mfma_f32_16x16x32_bf16 v[176:179], v[224:227], v[112:115], v[176:179]
    ds_read_b64_tr_b16 v[208:209], v17 offset:49152
    s_add_u32 m0, s55, 2048
    s_add_u32 s70, s70, 0x4000
    buffer_load_dwordx4 v13, s[32:35], s70 offen lds
    v_mfma_f32_16x16x32_bf16 v[184:187], v[224:227], v[116:119], v[184:187]
    ds_read_b64_tr_b16 v[210:211], v17 offset:49664
    ds_read_b64_tr_b16 v[88:89], v23 offset:49152
    v_mfma_f32_16x16x32_bf16 v[180:183], v[228:231], v[112:115], v[180:183]
    ds_read_b64_tr_b16 v[212:213], v18 offset:49152
    s_add_u32 m0, s55, 3072
    v_mfma_f32_16x16x32_bf16 v[188:191], v[228:231], v[116:119], v[188:191]
    ds_read_b64_tr_b16 v[214:215], v18 offset:49664
    ds_read_b64_tr_b16 v[90:91], v23 offset:51200
    v_mfma_f32_16x16x32_bf16 v[192:195], v[232:235], v[112:115], v[192:195]
    ds_read_b64_tr_b16 v[216:217], v19 offset:49152
    buffer_load_dwordx4 v14, s[32:35], s70 offen lds
    s_add_u32 m0, s55, 16384
    s_lshl4_add_u32 s70, s81, 0
    v_mfma_f32_16x16x32_bf16 v[200:203], v[232:235], v[116:119], v[200:203]
    ds_read_b64_tr_b16 v[218:219], v19 offset:49664
    ds_read_b64_tr_b16 v[92:93], v24 offset:49152
    v_mfma_f32_16x16x32_bf16 v[196:199], v[236:239], v[112:115], v[196:199]
    ds_read_b64_tr_b16 v[220:221], v20 offset:49152
    buffer_load_dwordx4 v13, s[32:35], s70 offen lds
    v_mfma_f32_16x16x32_bf16 v[204:207], v[236:239], v[116:119], v[204:207]
    ds_read_b64_tr_b16 v[222:223], v20 offset:49664
    ds_read_b64_tr_b16 v[94:95], v24 offset:51200
    s_waitcnt lgkmcnt(13)
    v_mfma_f32_16x16x32_bf16 v[176:179], v[240:243], v[120:123], v[176:179]
    ds_read_b64_tr_b16 v[224:225], v17 offset:53248
    s_add_u32 m0, s55, 17408
    v_mfma_f32_16x16x32_bf16 v[184:187], v[240:243], v[124:127], v[184:187]
    buffer_load_dwordx4 v14, s[32:35], s70 offen lds
    ds_read_b64_tr_b16 v[226:227], v17 offset:53760
    v_mfma_f32_16x16x32_bf16 v[180:183], v[244:247], v[120:123], v[180:183]
    ds_read_b64_tr_b16 v[228:229], v18 offset:53248
    s_add_u32 m0, s55, 18432
    s_add_u32 s70, s70, 0x4000
    v_mfma_f32_16x16x32_bf16 v[188:191], v[244:247], v[124:127], v[188:191]
    ds_read_b64_tr_b16 v[230:231], v18 offset:53760
    v_mfma_f32_16x16x32_bf16 v[192:195], v[248:251], v[120:123], v[192:195]
    ds_read_b64_tr_b16 v[232:233], v19 offset:53248
    buffer_load_dwordx4 v13, s[32:35], s70 offen lds
    v_mfma_f32_16x16x32_bf16 v[200:203], v[248:251], v[124:127], v[200:203]
    s_add_u32 m0, s55, 19456
    ds_read_b64_tr_b16 v[234:235], v19 offset:53760
    v_mfma_f32_16x16x32_bf16 v[196:199], v[252:255], v[120:123], v[196:199]
    ds_read_b64_tr_b16 v[236:237], v20 offset:53248
    buffer_load_dwordx4 v14, s[32:35], s70 offen lds
    v_mfma_f32_16x16x32_bf16 v[204:207], v[252:255], v[124:127], v[204:207]
    ds_read_b64_tr_b16 v[238:239], v20 offset:53760
    s_waitcnt vmcnt(20)
    s_waitcnt lgkmcnt(8)
    s_barrier
    v_mfma_f32_16x16x32_bf16 v[176:179], v[208:211], v[128:131], v[176:179]
    ds_read_b64_tr_b16 v[240:241], v17 offset:57344
    s_add_u32 m0, s91, 32768
    s_lshl4_add_u32 s70, s82, 0
    buffer_load_dwordx4 v13, s[32:35], s70 offen lds
    v_mfma_f32_16x16x32_bf16 v[184:187], v[208:211], v[132:135], v[184:187]
    ds_read_b64_tr_b16 v[242:243], v17 offset:57856
    v_add_u32 v21, 0x10000, v21
    v_mfma_f32_16x16x32_bf16 v[180:183], v[212:215], v[128:131], v[180:183]
    ds_read_b64_tr_b16 v[244:245], v18 offset:57344
    s_add_u32 m0, m0, s92
    v_mfma_f32_16x16x32_bf16 v[188:191], v[212:215], v[132:135], v[188:191]
    ds_read_b64_tr_b16 v[246:247], v18 offset:57856
    v_add_u32 v22, 0x10000, v22
    v_mfma_f32_16x16x32_bf16 v[192:195], v[216:219], v[128:131], v[192:195]
    ds_read_b64_tr_b16 v[248:249], v19 offset:57344
    buffer_load_dwordx4 v14, s[32:35], s70 offen lds
    s_add_u32 m0, m0, s92
    s_add_u32 s70, s70, 0x4000
    v_mfma_f32_16x16x32_bf16 v[200:203], v[216:219], v[132:135], v[200:203]
    ds_read_b64_tr_b16 v[250:251], v19 offset:57856
    v_add_u32 v23, 0x10000, v23
    v_mfma_f32_16x16x32_bf16 v[196:199], v[220:223], v[128:131], v[196:199]
    ds_read_b64_tr_b16 v[252:253], v20 offset:57344
    buffer_load_dwordx4 v13, s[32:35], s70 offen lds
    v_mfma_f32_16x16x32_bf16 v[204:207], v[220:223], v[132:135], v[204:207]
    ds_read_b64_tr_b16 v[254:255], v20 offset:57856
    v_add_u32 v24, 0x10000, v24
    s_waitcnt lgkmcnt(8)
    v_mfma_f32_16x16x32_bf16 v[176:179], v[224:227], v[136:139], v[176:179]
    ds_read_b64_tr_b16 v[208:209], v17 offset:61440
    s_add_u32 m0, m0, s92
    s_nop 0
    buffer_load_dwordx4 v14, s[32:35], s70 offen lds
    v_mfma_f32_16x16x32_bf16 v[184:187], v[224:227], v[140:143], v[184:187]
    ds_read_b64_tr_b16 v[210:211], v17 offset:61952
    ds_read_b64_tr_b16 v[96:97], v21 offset:0
    v_mfma_f32_16x16x32_bf16 v[180:183], v[228:231], v[136:139], v[180:183]
    ds_read_b64_tr_b16 v[212:213], v18 offset:61440
    s_add_u32 m0, s55, 49152
    s_lshl4_add_u32 s70, s83, 0xffea0000
    v_mfma_f32_16x16x32_bf16 v[188:191], v[228:231], v[140:143], v[188:191]
    ds_read_b64_tr_b16 v[214:215], v18 offset:61952
    ds_read_b64_tr_b16 v[98:99], v21 offset:2048
    v_mfma_f32_16x16x32_bf16 v[192:195], v[232:235], v[136:139], v[192:195]
    ds_read_b64_tr_b16 v[216:217], v19 offset:61440
    buffer_load_dwordx4 v13, s[36:39], s70 offen lds
    s_add_u32 m0, s55, 50176
    v_mfma_f32_16x16x32_bf16 v[200:203], v[232:235], v[140:143], v[200:203]
    ds_read_b64_tr_b16 v[218:219], v19 offset:61952
    ds_read_b64_tr_b16 v[100:101], v22 offset:0
    v_mfma_f32_16x16x32_bf16 v[196:199], v[236:239], v[136:139], v[196:199]
    ds_read_b64_tr_b16 v[220:221], v20 offset:61440
    buffer_load_dwordx4 v14, s[36:39], s70 offen lds
    v_mfma_f32_16x16x32_bf16 v[204:207], v[236:239], v[140:143], v[204:207]
    ds_read_b64_tr_b16 v[222:223], v20 offset:61952
    ds_read_b64_tr_b16 v[102:103], v22 offset:2048
    s_waitcnt lgkmcnt(12)
    v_mfma_f32_16x16x32_bf16 v[176:179], v[240:243], v[144:147], v[176:179]
    s_add_u32 m0, s55, 51200
    s_add_u32 s70, s70, 0x4000
    buffer_load_dwordx4 v13, s[36:39], s70 offen lds
    v_mfma_f32_16x16x32_bf16 v[184:187], v[240:243], v[148:151], v[184:187]
    ds_read_b64_tr_b16 v[104:105], v23 offset:0
    v_mfma_f32_16x16x32_bf16 v[180:183], v[244:247], v[144:147], v[180:183]
    s_add_u32 m0, s55, 52224
    v_mfma_f32_16x16x32_bf16 v[188:191], v[244:247], v[148:151], v[188:191]
    ds_read_b64_tr_b16 v[106:107], v23 offset:2048
    v_mfma_f32_16x16x32_bf16 v[192:195], v[248:251], v[144:147], v[192:195]
    buffer_load_dwordx4 v14, s[36:39], s70 offen lds
    s_add_u32 m0, s55, 131072
    s_lshl4_add_u32 s70, s84, 0xffea0000
    v_mfma_f32_16x16x32_bf16 v[200:203], v[248:251], v[148:151], v[200:203]
    ds_read_b64_tr_b16 v[108:109], v24 offset:0
    v_mfma_f32_16x16x32_bf16 v[196:199], v[252:255], v[144:147], v[196:199]
    buffer_load_dwordx4 v13, s[36:39], s70 offen lds
    v_mfma_f32_16x16x32_bf16 v[204:207], v[252:255], v[148:151], v[204:207]
    ds_read_b64_tr_b16 v[110:111], v24 offset:2048
    s_waitcnt lgkmcnt(5)
    v_mfma_f32_16x16x32_bf16 v[176:179], v[208:211], v[152:155], v[176:179]
    s_add_u32 m0, s55, 132096
    v_mfma_f32_16x16x32_bf16 v[184:187], v[208:211], v[156:159], v[184:187]
    buffer_load_dwordx4 v14, s[36:39], s70 offen lds
    v_mfma_f32_16x16x32_bf16 v[180:183], v[212:215], v[152:155], v[180:183]
    s_add_u32 m0, s55, 133120
    s_add_u32 s70, s70, 0x4000
    v_mfma_f32_16x16x32_bf16 v[188:191], v[212:215], v[156:159], v[188:191]
    v_mfma_f32_16x16x32_bf16 v[192:195], v[216:219], v[152:155], v[192:195]
    buffer_load_dwordx4 v13, s[36:39], s70 offen lds
    v_mfma_f32_16x16x32_bf16 v[200:203], v[216:219], v[156:159], v[200:203]
    s_add_u32 m0, s55, 134144
    v_mfma_f32_16x16x32_bf16 v[196:199], v[220:223], v[152:155], v[196:199]
    buffer_load_dwordx4 v14, s[36:39], s70 offen lds
    v_mfma_f32_16x16x32_bf16 v[204:207], v[220:223], v[156:159], v[204:207]
    s_waitcnt vmcnt(20)
    s_waitcnt lgkmcnt(0)
    s_barrier
    s_setprio 2
    s_cmp_eq_u32 s52, 1
    s_cbranch_scc1 L_G1B
    s_mov_b32 s64, 0x3fb8aa3b
    s_mov_b32 s65, 0x3fb8aa3b
    s_mov_b32 s63, 0x358637bd
    v_mov_b32 v8, 0xb5c1a2a0
    v_mov_b32 v9, 0xb5c1a2a0
    v_and_b32 v3, 15, v1
    v_lshlrev_b32 v3, 3, v3
    buffer_load_dwordx2 v[4:5], v3, s[24:27], s93 offen offset:0 sc1
    buffer_load_dwordx2 v[6:7], v3, s[24:27], s93 offen offset:128 sc1
    v_pk_fma_f32 v[240:241], v[176:177], s[64:65], v[8:9]
    v_pk_fma_f32 v[242:243], v[178:179], s[64:65], v[8:9]
    v_pk_fma_f32 v[244:245], v[180:181], s[64:65], v[8:9]
    v_pk_fma_f32 v[246:247], v[182:183], s[64:65], v[8:9]
    v_pk_fma_f32 v[248:249], v[184:185], s[64:65], v[8:9]
    v_pk_fma_f32 v[250:251], v[186:187], s[64:65], v[8:9]
    v_pk_fma_f32 v[252:253], v[188:189], s[64:65], v[8:9]
    v_pk_fma_f32 v[254:255], v[190:191], s[64:65], v[8:9]
    v_exp_f32_e64 v240, v240 clamp
    v_exp_f32_e64 v241, v241 clamp
    v_exp_f32_e64 v242, v242 clamp
    v_exp_f32_e64 v243, v243 clamp
    v_exp_f32_e64 v244, v244 clamp
    v_exp_f32_e64 v245, v245 clamp
    v_exp_f32_e64 v246, v246 clamp
    v_exp_f32_e64 v247, v247 clamp
    v_exp_f32_e64 v248, v248 clamp
    v_exp_f32_e64 v249, v249 clamp
    v_exp_f32_e64 v250, v250 clamp
    v_exp_f32_e64 v251, v251 clamp
    v_exp_f32_e64 v252, v252 clamp
    v_exp_f32_e64 v253, v253 clamp
    v_exp_f32_e64 v254, v254 clamp
    v_exp_f32_e64 v255, v255 clamp
    v_max_f32 v176, s63, v176
    v_max_f32 v177, s63, v177
    v_max_f32 v178, s63, v178
    v_max_f32 v179, s63, v179
    v_max_f32 v180, s63, v180
    v_max_f32 v181, s63, v181
    v_max_f32 v182, s63, v182
    v_max_f32 v183, s63, v183
    v_max_f32 v184, s63, v184
    v_max_f32 v185, s63, v185
    v_max_f32 v186, s63, v186
    v_max_f32 v187, s63, v187
    v_max_f32 v188, s63, v188
    v_max_f32 v189, s63, v189
    v_max_f32 v190, s63, v190
    v_max_f32 v191, s63, v191
    v_pk_add_f32 v[240:241], v[240:241], v[176:177]
    v_pk_add_f32 v[242:243], v[242:243], v[178:179]
    v_pk_add_f32 v[244:245], v[244:245], v[180:181]
    v_pk_add_f32 v[246:247], v[246:247], v[182:183]
    v_pk_add_f32 v[248:249], v[248:249], v[184:185]
    v_pk_add_f32 v[250:251], v[250:251], v[186:187]
    v_pk_add_f32 v[252:253], v[252:253], v[188:189]
    v_pk_add_f32 v[254:255], v[254:255], v[190:191]
    v_cvt_pk_bf16_f32 v144, v240, v241
    v_cvt_pk_bf16_f32 v145, v242, v243
    v_cvt_pk_bf16_f32 v146, v244, v245
    v_cvt_pk_bf16_f32 v147, v246, v247
    v_cvt_pk_bf16_f32 v148, v248, v249
    v_cvt_pk_bf16_f32 v149, v250, v251
    v_cvt_pk_bf16_f32 v150, v252, v253
    v_cvt_pk_bf16_f32 v151, v254, v255
    v_pk_fma_f32 v[240:241], v[192:193], s[64:65], v[8:9]
    v_pk_fma_f32 v[242:243], v[194:195], s[64:65], v[8:9]
    v_pk_fma_f32 v[244:245], v[196:197], s[64:65], v[8:9]
    v_pk_fma_f32 v[246:247], v[198:199], s[64:65], v[8:9]
    v_pk_fma_f32 v[248:249], v[200:201], s[64:65], v[8:9]
    v_pk_fma_f32 v[250:251], v[202:203], s[64:65], v[8:9]
    v_pk_fma_f32 v[252:253], v[204:205], s[64:65], v[8:9]
    v_pk_fma_f32 v[254:255], v[206:207], s[64:65], v[8:9]
    v_exp_f32_e64 v240, v240 clamp
    v_exp_f32_e64 v241, v241 clamp
    v_exp_f32_e64 v242, v242 clamp
    v_exp_f32_e64 v243, v243 clamp
    v_exp_f32_e64 v244, v244 clamp
    v_exp_f32_e64 v245, v245 clamp
    v_exp_f32_e64 v246, v246 clamp
    v_exp_f32_e64 v247, v247 clamp
    v_exp_f32_e64 v248, v248 clamp
    v_exp_f32_e64 v249, v249 clamp
    v_exp_f32_e64 v250, v250 clamp
    v_exp_f32_e64 v251, v251 clamp
    v_exp_f32_e64 v252, v252 clamp
    v_exp_f32_e64 v253, v253 clamp
    v_exp_f32_e64 v254, v254 clamp
    v_exp_f32_e64 v255, v255 clamp
    v_max_f32 v192, s63, v192
    v_max_f32 v193, s63, v193
    v_max_f32 v194, s63, v194
    v_max_f32 v195, s63, v195
    v_max_f32 v196, s63, v196
    v_max_f32 v197, s63, v197
    v_max_f32 v198, s63, v198
    v_max_f32 v199, s63, v199
    v_max_f32 v200, s63, v200
    v_max_f32 v201, s63, v201
    v_max_f32 v202, s63, v202
    v_max_f32 v203, s63, v203
    v_max_f32 v204, s63, v204
    v_max_f32 v205, s63, v205
    v_max_f32 v206, s63, v206
    v_max_f32 v207, s63, v207
    v_pk_add_f32 v[240:241], v[240:241], v[192:193]
    v_pk_add_f32 v[242:243], v[242:243], v[194:195]
    v_pk_add_f32 v[244:245], v[244:245], v[196:197]
    v_pk_add_f32 v[246:247], v[246:247], v[198:199]
    v_pk_add_f32 v[248:249], v[248:249], v[200:201]
    v_pk_add_f32 v[250:251], v[250:251], v[202:203]
    v_pk_add_f32 v[252:253], v[252:253], v[204:205]
    v_pk_add_f32 v[254:255], v[254:255], v[206:207]
    v_cvt_pk_bf16_f32 v152, v240, v241
    v_cvt_pk_bf16_f32 v153, v242, v243
    v_cvt_pk_bf16_f32 v154, v244, v245
    v_cvt_pk_bf16_f32 v155, v246, v247
    v_cvt_pk_bf16_f32 v156, v248, v249
    v_cvt_pk_bf16_f32 v157, v250, v251
    v_cvt_pk_bf16_f32 v158, v252, v253
    v_cvt_pk_bf16_f32 v159, v254, v255
    v_lshlrev_b32 v10, 3, v1
    v_lshrrev_b32 v11, 4, v1
    v_lshlrev_b32 v11, 3, v11
    s_waitcnt vmcnt(0)
    v_add_u32 v240, v5, v7
    v_cmp_ne_u32 vcc, s62, v240
    s_cbranch_vccnz L_slow2
L_back2:
    s_barrier
    ds_read_b64 v[248:249], v11 offset:47104
    ds_read_b64 v[240:241], v10 offset:45056
    ds_read_b64 v[250:251], v11 offset:47136
    ds_read_b64 v[242:243], v10 offset:45568
    ds_read_b64 v[252:253], v11 offset:47168
    ds_read_b64 v[244:245], v10 offset:46080
    ds_read_b64 v[254:255], v11 offset:47200
    ds_read_b64 v[246:247], v10 offset:46592
    s_waitcnt lgkmcnt(7)
    v_mfma_f32_16x16x16_bf16 v[208:211], v[248:249], v[144:145], 0
    v_mfma_f32_16x16x16_bf16 v[216:219], v[248:249], v[148:149], 0
    s_waitcnt lgkmcnt(5)
    v_mfma_f32_16x16x16_bf16 v[212:215], v[250:251], v[146:147], 0
    v_mfma_f32_16x16x16_bf16 v[220:223], v[250:251], v[150:151], 0
    s_waitcnt lgkmcnt(3)
    v_mfma_f32_16x16x16_bf16 v[224:227], v[252:253], v[152:153], 0
    v_mfma_f32_16x16x16_bf16 v[232:235], v[252:253], v[156:157], 0
    s_waitcnt lgkmcnt(1)
    v_mfma_f32_16x16x16_bf16 v[228:231], v[254:255], v[154:155], 0
    v_mfma_f32_16x16x16_bf16 v[236:239], v[254:255], v[158:159], 0
    v_mfma_f32_16x16x16_bf16 v[176:179], v[240:241], v[144:145], 0
    v_mfma_f32_16x16x16_bf16 v[184:187], v[240:241], v[148:149], 0
    v_mfma_f32_16x16x16_bf16 v[180:183], v[242:243], v[146:147], 0
    v_mfma_f32_16x16x16_bf16 v[188:191], v[242:243], v[150:151], 0
    v_mfma_f32_16x16x16_bf16 v[192:195], v[244:245], v[152:153], 0
    v_mfma_f32_16x16x16_bf16 v[200:203], v[244:245], v[156:157], 0
    s_waitcnt lgkmcnt(0)
    v_mfma_f32_16x16x16_bf16 v[196:199], v[246:247], v[154:155], 0
    v_mfma_f32_16x16x16_bf16 v[204:207], v[246:247], v[158:159], 0
    v_add_f32 v208, s63, v208
    v_add_f32 v212, s63, v212
    v_add_f32 v216, s63, v216
    v_add_f32 v220, s63, v220
    v_add_f32 v224, s63, v224
    v_add_f32 v228, s63, v228
    v_add_f32 v232, s63, v232
    v_add_f32 v236, s63, v236
    v_rcp_f32 v208, v208
    v_rcp_f32 v212, v212
    v_rcp_f32 v216, v216
    v_rcp_f32 v220, v220
    v_rcp_f32 v224, v224
    v_rcp_f32 v228, v228
    v_rcp_f32 v232, v232
    v_rcp_f32 v236, v236
    v_mul_f32 v208, v208, v4
    v_mul_f32 v212, v212, v4
    v_mul_f32 v216, v216, v6
    v_mul_f32 v220, v220, v6
    v_mul_f32 v224, v224, v4
    v_mul_f32 v228, v228, v4
    v_mul_f32 v232, v232, v6
    v_mul_f32 v236, v236, v6
    v_pk_mul_f32 v[176:177], v[176:177], v[208:209] op_sel_hi:[1,0]
    v_pk_mul_f32 v[178:179], v[178:179], v[208:209] op_sel_hi:[1,0]
    v_pk_mul_f32 v[180:181], v[180:181], v[212:213] op_sel_hi:[1,0]
    v_pk_mul_f32 v[182:183], v[182:183], v[212:213] op_sel_hi:[1,0]
    v_cvt_pk_bf16_f32 v144, v176, v177
    v_cvt_pk_bf16_f32 v145, v178, v179
    v_cvt_pk_bf16_f32 v146, v180, v181
    v_cvt_pk_bf16_f32 v147, v182, v183
    v_pk_mul_f32 v[184:185], v[184:185], v[216:217] op_sel_hi:[1,0]
    v_pk_mul_f32 v[186:187], v[186:187], v[216:217] op_sel_hi:[1,0]
    v_pk_mul_f32 v[188:189], v[188:189], v[220:221] op_sel_hi:[1,0]
    v_pk_mul_f32 v[190:191], v[190:191], v[220:221] op_sel_hi:[1,0]
    v_cvt_pk_bf16_f32 v148, v184, v185
    v_cvt_pk_bf16_f32 v149, v186, v187
    v_cvt_pk_bf16_f32 v150, v188, v189
    v_cvt_pk_bf16_f32 v151, v190, v191
    v_add3_u32 v242, v144, v145, v146
    buffer_store_dwordx4 v[144:147], v2, s[24:27], s87 offen offset:0 sc1
    v_add3_u32 v243, v147, v148, v149
    buffer_store_dwordx4 v[148:151], v2, s[24:27], s87 offen offset:1024 sc1
    v_add3_u32 v242, v242, v150, v151
    v_add_u32 v242, v242, v243
    v_sub_u32 v242, s61, v242
    buffer_store_dword v242, v12, s[24:27], s87 offen offset:0 sc1
    v_pk_mul_f32 v[192:193], v[192:193], v[224:225] op_sel_hi:[1,0]
    v_pk_mul_f32 v[194:195], v[194:195], v[224:225] op_sel_hi:[1,0]
    v_pk_mul_f32 v[196:197], v[196:197], v[228:229] op_sel_hi:[1,0]
    v_pk_mul_f32 v[198:199], v[198:199], v[228:229] op_sel_hi:[1,0]
    v_cvt_pk_bf16_f32 v152, v192, v193
    v_cvt_pk_bf16_f32 v153, v194, v195
    v_cvt_pk_bf16_f32 v154, v196, v197
    v_cvt_pk_bf16_f32 v155, v198, v199
    v_pk_mul_f32 v[200:201], v[200:201], v[232:233] op_sel_hi:[1,0]
    v_pk_mul_f32 v[202:203], v[202:203], v[232:233] op_sel_hi:[1,0]
    v_pk_mul_f32 v[204:205], v[204:205], v[236:237] op_sel_hi:[1,0]
    v_pk_mul_f32 v[206:207], v[206:207], v[236:237] op_sel_hi:[1,0]
    v_cvt_pk_bf16_f32 v156, v200, v201
    v_cvt_pk_bf16_f32 v157, v202, v203
    v_cvt_pk_bf16_f32 v158, v204, v205
    v_cvt_pk_bf16_f32 v159, v206, v207
    v_add3_u32 v246, v152, v153, v154
    buffer_store_dwordx4 v[152:155], v2, s[24:27], s87 offen offset:2048 sc1
    v_add3_u32 v247, v155, v156, v157
    buffer_store_dwordx4 v[156:159], v2, s[24:27], s87 offen offset:3072 sc1
    v_add3_u32 v246, v246, v158, v159
    v_add_u32 v246, v246, v247
    v_sub_u32 v246, s61, v246
    buffer_store_dword v246, v12, s[24:27], s87 offen offset:256 sc1
    s_branch L_P2_1
L_G1B:
    s_mov_b32 s64, 0xbdd2d3e8
    s_mov_b32 s65, 0xbdd2d3e8
    s_mov_b32 s63, 0x358637bd
    v_mov_b32 v8, 0xc0135761
    v_mov_b32 v9, 0xc0135761
    v_pk_mul_f32 v[240:241], v[176:177], v[176:177]
    v_pk_mul_f32 v[242:243], v[178:179], v[178:179]
    v_pk_mul_f32 v[244:245], v[180:181], v[180:181]
    v_pk_mul_f32 v[246:247], v[182:183], v[182:183]
    v_pk_mul_f32 v[248:249], v[184:185], v[184:185]
    v_pk_mul_f32 v[250:251], v[186:187], v[186:187]
    v_pk_mul_f32 v[252:253], v[188:189], v[188:189]
    v_pk_mul_f32 v[254:255], v[190:191], v[190:191]
    v_pk_fma_f32 v[240:241], v[240:241], s[64:65], v[8:9]
    v_pk_fma_f32 v[242:243], v[242:243], s[64:65], v[8:9]
    v_pk_fma_f32 v[244:245], v[244:245], s[64:65], v[8:9]
    v_pk_fma_f32 v[246:247], v[246:247], s[64:65], v[8:9]
    v_pk_fma_f32 v[248:249], v[248:249], s[64:65], v[8:9]
    v_pk_fma_f32 v[250:251], v[250:251], s[64:65], v[8:9]
    v_pk_fma_f32 v[252:253], v[252:253], s[64:65], v[8:9]
    v_pk_fma_f32 v[254:255], v[254:255], s[64:65], v[8:9]
    v_pk_mul_f32 v[240:241], v[176:177], v[240:241]
    v_pk_mul_f32 v[242:243], v[178:179], v[242:243]
    v_pk_mul_f32 v[244:245], v[180:181], v[244:245]
    v_pk_mul_f32 v[246:247], v[182:183], v[246:247]
    v_pk_mul_f32 v[248:249], v[184:185], v[248:249]
    v_pk_mul_f32 v[250:251], v[186:187], v[250:251]
    v_pk_mul_f32 v[252:253], v[188:189], v[252:253]
    v_pk_mul_f32 v[254:255], v[190:191], v[254:255]
    v_exp_f32 v240, v240
    v_exp_f32 v241, v241
    v_exp_f32 v242, v242
    v_exp_f32 v243, v243
    v_exp_f32 v244, v244
    v_exp_f32 v245, v245
    v_exp_f32 v246, v246
    v_exp_f32 v247, v247
    v_exp_f32 v248, v248
    v_exp_f32 v249, v249
    v_exp_f32 v250, v250
    v_exp_f32 v251, v251
    v_exp_f32 v252, v252
    v_exp_f32 v253, v253
    v_exp_f32 v254, v254
    v_exp_f32 v255, v255
    v_pk_add_f32 v[240:241], v[240:241], 1.0 op_sel_hi:[1,0]
    v_pk_add_f32 v[242:243], v[242:243], 1.0 op_sel_hi:[1,0]
    v_pk_add_f32 v[244:245], v[244:245], 1.0 op_sel_hi:[1,0]
    v_pk_add_f32 v[246:247], v[246:247], 1.0 op_sel_hi:[1,0]
    v_pk_add_f32 v[248:249], v[248:249], 1.0 op_sel_hi:[1,0]
    v_pk_add_f32 v[250:251], v[250:251], 1.0 op_sel_hi:[1,0]
    v_pk_add_f32 v[252:253], v[252:253], 1.0 op_sel_hi:[1,0]
    v_pk_add_f32 v[254:255], v[254:255], 1.0 op_sel_hi:[1,0]
    v_rcp_f32 v240, v240
    v_rcp_f32 v241, v241
    v_rcp_f32 v242, v242
    v_rcp_f32 v243, v243
    v_rcp_f32 v244, v244
    v_rcp_f32 v245, v245
    v_rcp_f32 v246, v246
    v_rcp_f32 v247, v247
    v_rcp_f32 v248, v248
    v_rcp_f32 v249, v249
    v_rcp_f32 v250, v250
    v_rcp_f32 v251, v251
    v_rcp_f32 v252, v252
    v_rcp_f32 v253, v253
    v_rcp_f32 v254, v254
    v_rcp_f32 v255, v255
    v_pk_mul_f32 v[240:241], v[176:177], v[240:241]
    v_pk_mul_f32 v[242:243], v[178:179], v[242:243]
    v_pk_mul_f32 v[244:245], v[180:181], v[244:245]
    v_pk_mul_f32 v[246:247], v[182:183], v[246:247]
    v_pk_mul_f32 v[248:249], v[184:185], v[248:249]
    v_pk_mul_f32 v[250:251], v[186:187], v[250:251]
    v_pk_mul_f32 v[252:253], v[188:189], v[252:253]
    v_pk_mul_f32 v[254:255], v[190:191], v[254:255]
    v_cvt_pk_bf16_f32 v208, v240, v241
    v_cvt_pk_bf16_f32 v209, v242, v243
    v_cvt_pk_bf16_f32 v210, v244, v245
    v_cvt_pk_bf16_f32 v211, v246, v247
    v_cvt_pk_bf16_f32 v212, v248, v249
    v_cvt_pk_bf16_f32 v213, v250, v251
    v_cvt_pk_bf16_f32 v214, v252, v253
    v_cvt_pk_bf16_f32 v215, v254, v255
    v_add3_u32 v224, v208, v209, v210
    buffer_store_dwordx4 v[208:211], v2, s[24:27], s87 offen offset:0 sc1
    v_add3_u32 v225, v211, v212, v213
    buffer_store_dwordx4 v[212:215], v2, s[24:27], s87 offen offset:1024 sc1
    v_add3_u32 v224, v224, v214, v215
    v_add_u32 v224, v224, v225
    v_sub_u32 v224, s61, v224
    buffer_store_dword v224, v12, s[24:27], s87 offen offset:0 sc1
    v_pk_mul_f32 v[240:241], v[192:193], v[192:193]
    v_pk_mul_f32 v[242:243], v[194:195], v[194:195]
    v_pk_mul_f32 v[244:245], v[196:197], v[196:197]
    v_pk_mul_f32 v[246:247], v[198:199], v[198:199]
    v_pk_mul_f32 v[248:249], v[200:201], v[200:201]
    v_pk_mul_f32 v[250:251], v[202:203], v[202:203]
    v_pk_mul_f32 v[252:253], v[204:205], v[204:205]
    v_pk_mul_f32 v[254:255], v[206:207], v[206:207]
    v_pk_fma_f32 v[240:241], v[240:241], s[64:65], v[8:9]
    v_pk_fma_f32 v[242:243], v[242:243], s[64:65], v[8:9]
    v_pk_fma_f32 v[244:245], v[244:245], s[64:65], v[8:9]
    v_pk_fma_f32 v[246:247], v[246:247], s[64:65], v[8:9]
    v_pk_fma_f32 v[248:249], v[248:249], s[64:65], v[8:9]
    v_pk_fma_f32 v[250:251], v[250:251], s[64:65], v[8:9]
    v_pk_fma_f32 v[252:253], v[252:253], s[64:65], v[8:9]
    v_pk_fma_f32 v[254:255], v[254:255], s[64:65], v[8:9]
    v_pk_mul_f32 v[240:241], v[192:193], v[240:241]
    v_pk_mul_f32 v[242:243], v[194:195], v[242:243]
    v_pk_mul_f32 v[244:245], v[196:197], v[244:245]
    v_pk_mul_f32 v[246:247], v[198:199], v[246:247]
    v_pk_mul_f32 v[248:249], v[200:201], v[248:249]
    v_pk_mul_f32 v[250:251], v[202:203], v[250:251]
    v_pk_mul_f32 v[252:253], v[204:205], v[252:253]
    v_pk_mul_f32 v[254:255], v[206:207], v[254:255]
    v_exp_f32 v240, v240
    v_exp_f32 v241, v241
    v_exp_f32 v242, v242
    v_exp_f32 v243, v243
    v_exp_f32 v244, v244
    v_exp_f32 v245, v245
    v_exp_f32 v246, v246
    v_exp_f32 v247, v247
    v_exp_f32 v248, v248
    v_exp_f32 v249, v249
    v_exp_f32 v250, v250
    v_exp_f32 v251, v251
    v_exp_f32 v252, v252
    v_exp_f32 v253, v253
    v_exp_f32 v254, v254
    v_exp_f32 v255, v255
    v_pk_add_f32 v[240:241], v[240:241], 1.0 op_sel_hi:[1,0]
    v_pk_add_f32 v[242:243], v[242:243], 1.0 op_sel_hi:[1,0]
    v_pk_add_f32 v[244:245], v[244:245], 1.0 op_sel_hi:[1,0]
    v_pk_add_f32 v[246:247], v[246:247], 1.0 op_sel_hi:[1,0]
    v_pk_add_f32 v[248:249], v[248:249], 1.0 op_sel_hi:[1,0]
    v_pk_add_f32 v[250:251], v[250:251], 1.0 op_sel_hi:[1,0]
    v_pk_add_f32 v[252:253], v[252:253], 1.0 op_sel_hi:[1,0]
    v_pk_add_f32 v[254:255], v[254:255], 1.0 op_sel_hi:[1,0]
    v_rcp_f32 v240, v240
    v_rcp_f32 v241, v241
    v_rcp_f32 v242, v242
    v_rcp_f32 v243, v243
    v_rcp_f32 v244, v244
    v_rcp_f32 v245, v245
    v_rcp_f32 v246, v246
    v_rcp_f32 v247, v247
    v_rcp_f32 v248, v248
    v_rcp_f32 v249, v249
    v_rcp_f32 v250, v250
    v_rcp_f32 v251, v251
    v_rcp_f32 v252, v252
    v_rcp_f32 v253, v253
    v_rcp_f32 v254, v254
    v_rcp_f32 v255, v255
    v_pk_mul_f32 v[240:241], v[192:193], v[240:241]
    v_pk_mul_f32 v[242:243], v[194:195], v[242:243]
    v_pk_mul_f32 v[244:245], v[196:197], v[244:245]
    v_pk_mul_f32 v[246:247], v[198:199], v[246:247]
    v_pk_mul_f32 v[248:249], v[200:201], v[248:249]
    v_pk_mul_f32 v[250:251], v[202:203], v[250:251]
    v_pk_mul_f32 v[252:253], v[204:205], v[252:253]
    v_pk_mul_f32 v[254:255], v[206:207], v[254:255]
    v_cvt_pk_bf16_f32 v216, v240, v241
    v_cvt_pk_bf16_f32 v217, v242, v243
    v_cvt_pk_bf16_f32 v218, v244, v245
    v_cvt_pk_bf16_f32 v219, v246, v247
    v_cvt_pk_bf16_f32 v220, v248, v249
    v_cvt_pk_bf16_f32 v221, v250, v251
    v_cvt_pk_bf16_f32 v222, v252, v253
    v_cvt_pk_bf16_f32 v223, v254, v255
    v_add3_u32 v226, v216, v217, v218
    buffer_store_dwordx4 v[216:219], v2, s[24:27], s87 offen offset:2048 sc1
    v_add3_u32 v227, v219, v220, v221
    buffer_store_dwordx4 v[220:223], v2, s[24:27], s87 offen offset:3072 sc1
    v_add3_u32 v226, v226, v222, v223
    v_add_u32 v226, v226, v227
    v_sub_u32 v226, s61, v226
    buffer_store_dword v226, v12, s[24:27], s87 offen offset:256 sc1
L_P2_1:
    s_nop 1
    s_setprio 0
    buffer_load_dwordx4 v[112:115], v25, s[24:27], s72 offen sc1
    buffer_load_dwordx4 v[116:119], v26, s[24:27], s72 offen sc1
    buffer_load_dword v160, v27, s[24:27], s72 offen sc1
    buffer_load_dwordx4 v[120:123], v25, s[24:27], s73 offen sc1
    buffer_load_dwordx4 v[124:127], v26, s[24:27], s73 offen sc1
    buffer_load_dword v161, v27, s[24:27], s73 offen sc1
    buffer_load_dwordx4 v[128:131], v25, s[24:27], s74 offen sc1
    buffer_load_dwordx4 v[132:135], v26, s[24:27], s74 offen sc1
    buffer_load_dword v162, v27, s[24:27], s74 offen sc1
    s_waitcnt vmcnt(6)
    v_add3_u32 v248, v160, v112, v113
    v_add3_u32 v249, v114, v115, v116
    v_add3_u32 v248, v248, v117, v118
    v_add3_u32 v248, v248, v249, v119
    v_cmp_ne_u32 vcc, s61, v248
    s_cbranch_vccnz L_slow3
L_back3:
    v_mfma_f32_16x16x32_bf16 v[184:187], v[32:35], v[116:119], 0
    v_and_b32 v243, 0xffff0000, v29
    v_lshlrev_b32 v242, 16, v29
    v_and_b32 v241, 0xffff0000, v28
    v_lshlrev_b32 v240, 16, v28
    v_and_b32 v247, 0xffff0000, v31
    v_mfma_f32_16x16x32_bf16 v[188:191], v[36:39], v[116:119], 0
    v_lshlrev_b32 v246, 16, v31
    v_and_b32 v245, 0xffff0000, v30
    v_lshlrev_b32 v244, 16, v30
    ds_read_b64_tr_b16 v[224:225], v21 offset:16384
    v_mfma_f32_16x16x32_bf16 v[192:195], v[40:43], v[112:115], 0
    ds_read_b64_tr_b16 v[226:227], v21 offset:18432
    ds_read_b64_tr_b16 v[228:229], v22 offset:16384
    ds_read_b64_tr_b16 v[230:231], v22 offset:18432
    ds_read_b64_tr_b16 v[232:233], v23 offset:16384
    ds_read_b64_tr_b16 v[234:235], v23 offset:18432
    v_mfma_f32_16x16x32_bf16 v[196:199], v[44:47], v[112:115], 0
    ds_read_b64_tr_b16 v[236:237], v24 offset:16384
    ds_read_b64_tr_b16 v[238:239], v24 offset:18432
    v_mfma_f32_16x16x32_bf16 v[200:203], v[40:43], v[116:119], 0
    v_mfma_f32_16x16x32_bf16 v[204:207], v[44:47], v[116:119], 0
    v_mfma_f32_16x16x32_bf16 v[176:179], v[32:35], v[112:115], v[240:243]
    s_waitcnt vmcnt(3)
    v_add3_u32 v248, v161, v120, v121
    v_add3_u32 v249, v122, v123, v124
    v_mfma_f32_16x16x32_bf16 v[180:183], v[36:39], v[112:115], v[244:247]
    v_add3_u32 v248, v248, v125, v126
    v_add3_u32 v248, v248, v249, v127
    v_cmp_ne_u32 vcc, s61, v248
    s_cbranch_vccnz L_slow4
L_back4:
    v_mfma_f32_16x16x32_bf16 v[184:187], v[48:51], v[124:127], v[184:187]
    buffer_load_dwordx4 v[136:139], v25, s[24:27], s75 offen sc1
    buffer_load_dwordx4 v[140:143], v26, s[24:27], s75 offen sc1
    buffer_load_dword v163, v27, s[24:27], s75 offen sc1
    ds_read_b64_tr_b16 v[208:209], v21 offset:32768
    ds_read_b64_tr_b16 v[210:211], v21 offset:34816
    v_mfma_f32_16x16x32_bf16 v[188:191], v[52:55], v[124:127], v[188:191]
    ds_read_b64_tr_b16 v[212:213], v22 offset:32768
    ds_read_b64_tr_b16 v[214:215], v22 offset:34816
    ds_read_b64_tr_b16 v[216:217], v23 offset:32768
    ds_read_b64_tr_b16 v[218:219], v23 offset:34816
    v_mfma_f32_16x16x32_bf16 v[192:195], v[56:59], v[120:123], v[192:195]
    ds_read_b64_tr_b16 v[220:221], v24 offset:32768
    ds_read_b64_tr_b16 v[222:223], v24 offset:34816
    v_mfma_f32_16x16x32_bf16 v[196:199], v[60:63], v[120:123], v[196:199]
    v_mfma_f32_16x16x32_bf16 v[200:203], v[56:59], v[124:127], v[200:203]
    v_mfma_f32_16x16x32_bf16 v[204:207], v[60:63], v[124:127], v[204:207]
    v_mfma_f32_16x16x32_bf16 v[176:179], v[48:51], v[120:123], v[176:179]
    s_waitcnt vmcnt(3)
    v_add3_u32 v248, v162, v128, v129
    v_add3_u32 v249, v130, v131, v132
    v_mfma_f32_16x16x32_bf16 v[180:183], v[52:55], v[120:123], v[180:183]
    v_add3_u32 v248, v248, v133, v134
    v_add3_u32 v248, v248, v249, v135
    v_cmp_ne_u32 vcc, s61, v248
    s_cbranch_vccnz L_slow5
L_back5:
    v_mfma_f32_16x16x32_bf16 v[184:187], v[64:67], v[132:135], v[184:187]
    buffer_load_dwordx4 v[144:147], v25, s[24:27], s76 offen sc1
    buffer_load_dwordx4 v[148:151], v26, s[24:27], s76 offen sc1
    buffer_load_dword v164, v27, s[24:27], s76 offen sc1
    ds_read_b64_tr_b16 v[112:113], v21 offset:49152
    ds_read_b64_tr_b16 v[114:115], v21 offset:51200
    v_mfma_f32_16x16x32_bf16 v[188:191], v[68:71], v[132:135], v[188:191]
    ds_read_b64_tr_b16 v[116:117], v22 offset:49152
    ds_read_b64_tr_b16 v[118:119], v22 offset:51200
    ds_read_b64_tr_b16 v[120:121], v23 offset:49152
    ds_read_b64_tr_b16 v[122:123], v23 offset:51200
    v_mfma_f32_16x16x32_bf16 v[192:195], v[72:75], v[128:131], v[192:195]
    ds_read_b64_tr_b16 v[124:125], v24 offset:49152
    ds_read_b64_tr_b16 v[126:127], v24 offset:51200
    v_mfma_f32_16x16x32_bf16 v[196:199], v[76:79], v[128:131], v[196:199]
    v_mfma_f32_16x16x32_bf16 v[200:203], v[72:75], v[132:135], v[200:203]
    v_mfma_f32_16x16x32_bf16 v[204:207], v[76:79], v[132:135], v[204:207]
    v_mfma_f32_16x16x32_bf16 v[176:179], v[64:67], v[128:131], v[176:179]
    s_waitcnt vmcnt(3)
    v_add3_u32 v248, v163, v136, v137
    v_add3_u32 v249, v138, v139, v140
    v_mfma_f32_16x16x32_bf16 v[180:183], v[68:71], v[128:131], v[180:183]
    v_add3_u32 v248, v248, v141, v142
    v_add3_u32 v248, v248, v249, v143
    v_cmp_ne_u32 vcc, s61, v248
    s_cbranch_vccnz L_slow6
L_back6:
    v_mfma_f32_16x16x32_bf16 v[184:187], v[80:83], v[140:143], v[184:187]
    buffer_load_dwordx4 v[152:155], v25, s[24:27], s77 offen sc1
    buffer_load_dwordx4 v[156:159], v26, s[24:27], s77 offen sc1
    buffer_load_dword v165, v27, s[24:27], s77 offen sc1
    s_lshl1_add_u32 s66, s57, 1
    s_lshl_b32 s93, s66, 8
    v_mfma_f32_16x16x32_bf16 v[188:191], v[84:87], v[140:143], v[188:191]
    s_add_u32 s93, s93, 9437184
    s_and_b32 s67, s49, 1
    s_lshl_b32 s68, s67, 7
    v_and_b32 v3, 15, v1
    v_mfma_f32_16x16x32_bf16 v[192:195], v[88:91], v[136:139], v[192:195]
    v_lshlrev_b32 v4, 3, v3
    v_add_u32 v4, s68, v4
    v_xor_b32 v5, 0x80, v4
    buffer_load_dwordx2 v[252:253], v4, s[24:27], s93 offen sc1
    buffer_load_dwordx2 v[254:255], v5, s[24:27], s93 offen sc1
    v_mfma_f32_16x16x32_bf16 v[196:199], v[92:95], v[136:139], v[196:199]
    v_mfma_f32_16x16x32_bf16 v[200:203], v[88:91], v[140:143], v[200:203]
    v_mfma_f32_16x16x32_bf16 v[204:207], v[92:95], v[140:143], v[204:207]
    v_mfma_f32_16x16x32_bf16 v[176:179], v[80:83], v[136:139], v[176:179]
    s_waitcnt vmcnt(5)
    v_add3_u32 v248, v164, v144, v145
    v_add3_u32 v249, v146, v147, v148
    v_mfma_f32_16x16x32_bf16 v[180:183], v[84:87], v[136:139], v[180:183]
    v_add3_u32 v248, v248, v149, v150
    v_add3_u32 v248, v248, v249, v151
    v_cmp_ne_u32 vcc, s61, v248
    s_cbranch_vccnz L_slow7
L_back7:
    v_mfma_f32_16x16x32_bf16 v[184:187], v[96:99], v[148:151], v[184:187]
    buffer_load_dwordx4 v[32:35], v25, s[24:27], s78 offen sc1
    buffer_load_dwordx4 v[36:39], v26, s[24:27], s78 offen sc1
    buffer_load_dword v166, v27, s[24:27], s78 offen sc1
    s_lshl1_add_u32 s66, s66, s67
    s_lshl_b32 s71, s66, 14
    v_mfma_f32_16x16x32_bf16 v[188:191], v[100:103], v[148:151], v[188:191]
    s_lshl_b32 s66, s58, 7
    s_add_u32 s71, s71, s66
    s_and_b32 s66, s49, 2
    s_lshl_b32 s66, s66, 5
    v_mfma_f32_16x16x32_bf16 v[192:195], v[104:107], v[144:147], v[192:195]
    s_add_u32 s71, s71, s66
    v_lshlrev_b32 v3, 10, v3
    v_and_b32 v6, 16, v1
    v_lshl_add_u32 v3, v6, 1, v3
    v_lshrrev_b32 v6, 5, v1
    v_mfma_f32_16x16x32_bf16 v[196:199], v[108:111], v[144:147], v[196:199]
    v_lshl_add_u32 v3, v6, 4, v3
    v_mfma_f32_16x16x32_bf16 v[200:203], v[104:107], v[148:151], v[200:203]
    v_mfma_f32_16x16x32_bf16 v[204:207], v[108:111], v[148:151], v[204:207]
    v_mfma_f32_16x16x32_bf16 v[176:179], v[96:99], v[144:147], v[176:179]
    s_waitcnt vmcnt(5)
    v_add3_u32 v248, v165, v152, v153
    v_add3_u32 v249, v154, v155, v156
    v_mfma_f32_16x16x32_bf16 v[180:183], v[100:103], v[144:147], v[180:183]
    v_add3_u32 v248, v248, v157, v158
    v_add3_u32 v248, v248, v249, v159
    v_cmp_ne_u32 vcc, s61, v248
    s_cbranch_vccnz L_slow8
L_back8:
    s_waitcnt lgkmcnt(0)
    s_barrier
    v_mfma_f32_16x16x32_bf16 v[184:187], v[224:227], v[156:159], v[184:187]
    buffer_load_dwordx4 v[40:43], v25, s[24:27], s79 offen sc1
    buffer_load_dwordx4 v[44:47], v26, s[24:27], s79 offen sc1
    buffer_load_dword v167, v27, s[24:27], s79 offen sc1
    v_add_u32 v21, 0xffff0000, v21
    v_add_u32 v22, 0xffff0000, v22
    v_mfma_f32_16x16x32_bf16 v[188:191], v[228:231], v[156:159], v[188:191]
    v_add_u32 v23, 0xffff0000, v23
    v_add_u32 v24, 0xffff0000, v24
    ds_read_b64_tr_b16 v[128:129], v21 offset:0
    ds_read_b64_tr_b16 v[130:131], v21 offset:2048
    v_mfma_f32_16x16x32_bf16 v[192:195], v[232:235], v[152:155], v[192:195]
    ds_read_b64_tr_b16 v[132:133], v22 offset:0
    ds_read_b64_tr_b16 v[134:135], v22 offset:2048
    ds_read_b64_tr_b16 v[136:137], v23 offset:0
    ds_read_b64_tr_b16 v[138:139], v23 offset:2048
    ds_read_b64_tr_b16 v[140:141], v24 offset:0
    v_mfma_f32_16x16x32_bf16 v[196:199], v[236:239], v[152:155], v[196:199]
    ds_read_b64_tr_b16 v[142:143], v24 offset:2048
    v_mfma_f32_16x16x32_bf16 v[200:203], v[232:235], v[156:159], v[200:203]
    v_mfma_f32_16x16x32_bf16 v[204:207], v[236:239], v[156:159], v[204:207]
    v_mfma_f32_16x16x32_bf16 v[176:179], v[224:227], v[152:155], v[176:179]
    s_waitcnt vmcnt(3)
    v_add3_u32 v248, v166, v32, v33
    v_add3_u32 v249, v34, v35, v36
    v_mfma_f32_16x16x32_bf16 v[180:183], v[228:231], v[152:155], v[180:183]
    v_add3_u32 v248, v248, v37, v38
    v_add3_u32 v248, v248, v249, v39
    v_cmp_ne_u32 vcc, s61, v248
    s_cbranch_vccnz L_slow9
L_back9:
    v_mfma_f32_16x16x32_bf16 v[184:187], v[208:211], v[36:39], v[184:187]
    buffer_load_dwordx4 v[48:51], v25, s[24:27], s80 offen sc1
    buffer_load_dwordx4 v[52:55], v26, s[24:27], s80 offen sc1
    buffer_load_dword v168, v27, s[24:27], s80 offen sc1
    ds_read_b64_tr_b16 v[144:145], v21 offset:16384
    ds_read_b64_tr_b16 v[146:147], v21 offset:18432
    v_mfma_f32_16x16x32_bf16 v[188:191], v[212:215], v[36:39], v[188:191]
    ds_read_b64_tr_b16 v[148:149], v22 offset:16384
    ds_read_b64_tr_b16 v[150:151], v22 offset:18432
    ds_read_b64_tr_b16 v[152:153], v23 offset:16384
    ds_read_b64_tr_b16 v[154:155], v23 offset:18432
    v_mfma_f32_16x16x32_bf16 v[192:195], v[216:219], v[32:35], v[192:195]
    ds_read_b64_tr_b16 v[156:157], v24 offset:16384
    ds_read_b64_tr_b16 v[158:159], v24 offset:18432
    v_mfma_f32_16x16x32_bf16 v[196:199], v[220:223], v[32:35], v[196:199]
    v_mfma_f32_16x16x32_bf16 v[200:203], v[216:219], v[36:39], v[200:203]
    v_mfma_f32_16x16x32_bf16 v[204:207], v[220:223], v[36:39], v[204:207]
    v_mfma_f32_16x16x32_bf16 v[176:179], v[208:211], v[32:35], v[176:179]
    s_waitcnt vmcnt(3)
    v_add3_u32 v248, v167, v40, v41
    v_add3_u32 v249, v42, v43, v44
    v_mfma_f32_16x16x32_bf16 v[180:183], v[212:215], v[32:35], v[180:183]
    v_add3_u32 v248, v248, v45, v46
    v_add3_u32 v248, v248, v249, v47
    v_cmp_ne_u32 vcc, s61, v248
    s_cbranch_vccnz L_slow10
L_back10:
    v_mfma_f32_16x16x32_bf16 v[184:187], v[112:115], v[44:47], v[184:187]
    buffer_load_dwordx4 v[56:59], v25, s[24:27], s81 offen sc1
    buffer_load_dwordx4 v[60:63], v26, s[24:27], s81 offen sc1
    buffer_load_dword v169, v27, s[24:27], s81 offen sc1
    ds_read_b64_tr_b16 v[224:225], v21 offset:32768
    ds_read_b64_tr_b16 v[226:227], v21 offset:34816
    v_mfma_f32_16x16x32_bf16 v[188:191], v[116:119], v[44:47], v[188:191]
    ds_read_b64_tr_b16 v[228:229], v22 offset:32768
    ds_read_b64_tr_b16 v[230:231], v22 offset:34816
    ds_read_b64_tr_b16 v[232:233], v23 offset:32768
    ds_read_b64_tr_b16 v[234:235], v23 offset:34816
    v_mfma_f32_16x16x32_bf16 v[192:195], v[120:123], v[40:43], v[192:195]
    ds_read_b64_tr_b16 v[236:237], v24 offset:32768
    ds_read_b64_tr_b16 v[238:239], v24 offset:34816
    v_mfma_f32_16x16x32_bf16 v[196:199], v[124:127], v[40:43], v[196:199]
    v_mfma_f32_16x16x32_bf16 v[200:203], v[120:123], v[44:47], v[200:203]
    v_mfma_f32_16x16x32_bf16 v[204:207], v[124:127], v[44:47], v[204:207]
    v_mfma_f32_16x16x32_bf16 v[176:179], v[112:115], v[40:43], v[176:179]
    s_waitcnt vmcnt(3)
    v_add3_u32 v248, v168, v48, v49
    v_add3_u32 v249, v50, v51, v52
    v_mfma_f32_16x16x32_bf16 v[180:183], v[116:119], v[40:43], v[180:183]
    v_add3_u32 v248, v248, v53, v54
    v_add3_u32 v248, v248, v249, v55
    v_cmp_ne_u32 vcc, s61, v248
    s_cbranch_vccnz L_slow11
L_back11:
    s_waitcnt lgkmcnt(15)
    v_mfma_f32_16x16x32_bf16 v[184:187], v[128:131], v[52:55], v[184:187]
    buffer_load_dwordx4 v[64:67], v25, s[24:27], s82 offen sc1
    buffer_load_dwordx4 v[68:71], v26, s[24:27], s82 offen sc1
    buffer_load_dword v170, v27, s[24:27], s82 offen sc1
    ds_read_b64_tr_b16 v[208:209], v21 offset:49152
    ds_read_b64_tr_b16 v[210:211], v21 offset:51200
    v_mfma_f32_16x16x32_bf16 v[188:191], v[132:135], v[52:55], v[188:191]
    ds_read_b64_tr_b16 v[212:213], v22 offset:49152
    ds_read_b64_tr_b16 v[214:215], v22 offset:51200
    ds_read_b64_tr_b16 v[216:217], v23 offset:49152
    ds_read_b64_tr_b16 v[218:219], v23 offset:51200
    v_mfma_f32_16x16x32_bf16 v[192:195], v[136:139], v[48:51], v[192:195]
    ds_read_b64_tr_b16 v[220:221], v24 offset:49152
    ds_read_b64_tr_b16 v[222:223], v24 offset:51200
    v_mfma_f32_16x16x32_bf16 v[196:199], v[140:143], v[48:51], v[196:199]
    v_mfma_f32_16x16x32_bf16 v[200:203], v[136:139], v[52:55], v[200:203]
    v_mfma_f32_16x16x32_bf16 v[204:207], v[140:143], v[52:55], v[204:207]
    v_mfma_f32_16x16x32_bf16 v[176:179], v[128:131], v[48:51], v[176:179]
    s_waitcnt vmcnt(3)
    v_add3_u32 v248, v169, v56, v57
    v_add3_u32 v249, v58, v59, v60
    v_mfma_f32_16x16x32_bf16 v[180:183], v[132:135], v[48:51], v[180:183]
    v_add3_u32 v248, v248, v61, v62
    v_add3_u32 v248, v248, v249, v63
    v_cmp_ne_u32 vcc, s61, v248
    s_cbranch_vccnz L_slow12
L_back12:
    s_waitcnt lgkmcnt(15)
    v_mfma_f32_16x16x32_bf16 v[184:187], v[144:147], v[60:63], v[184:187]
    buffer_load_dwordx4 v[72:75], v25, s[24:27], s83 offen sc1
    buffer_load_dwordx4 v[76:79], v26, s[24:27], s83 offen sc1
    buffer_load_dword v171, v27, s[24:27], s83 offen sc1
    v_add_u32 v21, 0x20000, v21
    v_add_u32 v22, 0x20000, v22
    v_mfma_f32_16x16x32_bf16 v[188:191], v[148:151], v[60:63], v[188:191]
    v_add_u32 v23, 0x20000, v23
    v_add_u32 v24, 0x20000, v24
    ds_read_b64_tr_b16 v[112:113], v21 offset:0
    ds_read_b64_tr_b16 v[114:115], v21 offset:2048
    v_mfma_f32_16x16x32_bf16 v[192:195], v[152:155], v[56:59], v[192:195]
    ds_read_b64_tr_b16 v[116:117], v22 offset:0
    ds_read_b64_tr_b16 v[118:119], v22 offset:2048
    ds_read_b64_tr_b16 v[120:121], v23 offset:0
    ds_read_b64_tr_b16 v[122:123], v23 offset:2048
    ds_read_b64_tr_b16 v[124:125], v24 offset:0
    v_mfma_f32_16x16x32_bf16 v[196:199], v[156:159], v[56:59], v[196:199]
    ds_read_b64_tr_b16 v[126:127], v24 offset:2048
    v_add_u32 v248, v253, v255
    v_cmp_ne_u32 vcc, s62, v248
    s_cbranch_vccnz L_slow13
L_back13:
    v_mfma_f32_16x16x32_bf16 v[200:203], v[152:155], v[60:63], v[200:203]
    v_mfma_f32_16x16x32_bf16 v[204:207], v[156:159], v[60:63], v[204:207]
    v_mfma_f32_16x16x32_bf16 v[176:179], v[144:147], v[56:59], v[176:179]
    s_waitcnt vmcnt(3)
    v_add3_u32 v248, v170, v64, v65
    v_add3_u32 v249, v66, v67, v68
    v_mfma_f32_16x16x32_bf16 v[180:183], v[148:151], v[56:59], v[180:183]
    v_add3_u32 v248, v248, v69, v70
    v_add3_u32 v248, v248, v249, v71
    v_cmp_ne_u32 vcc, s23, v248
    s_cbranch_vccnz L_slow14
L_back14:
    s_waitcnt lgkmcnt(15)
    v_mfma_f32_16x16x32_bf16 v[184:187], v[224:227], v[68:71], v[184:187]
    v_sub_f32 v252, 1.0, v252
    v_sub_f32 v254, 1.0, v254
    buffer_load_dwordx4 v[80:83], v25, s[24:27], s84 offen sc1
    buffer_load_dwordx4 v[84:87], v26, s[24:27], s84 offen sc1
    buffer_load_dword v172, v27, s[24:27], s84 offen sc1
    ds_read_b64_tr_b16 v[128:129], v21 offset:16384
    ds_read_b64_tr_b16 v[130:131], v21 offset:18432
    ds_read_b64_tr_b16 v[132:133], v22 offset:16384
    v_mfma_f32_16x16x32_bf16 v[188:191], v[228:231], v[68:71], v[188:191]
    ds_read_b64_tr_b16 v[134:135], v22 offset:18432
    ds_read_b64_tr_b16 v[136:137], v23 offset:16384
    ds_read_b64_tr_b16 v[138:139], v23 offset:18432
    ds_read_b64_tr_b16 v[140:141], v24 offset:16384
    ds_read_b64_tr_b16 v[142:143], v24 offset:18432
    v_mfma_f32_16x16x32_bf16 v[192:195], v[232:235], v[64:67], v[192:195]
    v_mfma_f32_16x16x32_bf16 v[196:199], v[236:239], v[64:67], v[196:199]
    v_mfma_f32_16x16x32_bf16 v[200:203], v[232:235], v[68:71], v[200:203]
    v_mul_f32 v184, v254, v184
    v_mul_f32 v185, v254, v185
    v_mul_f32 v186, v254, v186
    v_mul_f32 v187, v254, v187
    s_waitcnt vmcnt(3)
    v_add3_u32 v248, v171, v72, v73
    v_add3_u32 v249, v74, v75, v76
    v_add3_u32 v248, v248, v77, v78
    v_add3_u32 v248, v248, v249, v79
    v_cmp_ne_u32 vcc, s61, v248
    s_cbranch_vccnz L_slow15
L_back15:
    v_mfma_f32_16x16x32_bf16 v[204:207], v[236:239], v[68:71], v[204:207]
    v_mul_f32 v188, v254, v188
    v_mul_f32 v189, v254, v189
    v_mul_f32 v190, v254, v190
    v_mul_f32 v191, v254, v191
    v_mfma_f32_16x16x32_bf16 v[176:179], v[224:227], v[64:67], v[176:179]
    v_mul_f32 v192, v252, v192
    v_mul_f32 v193, v252, v193
    v_mul_f32 v194, v252, v194
    v_mul_f32 v195, v252, v195
    v_mfma_f32_16x16x32_bf16 v[180:183], v[228:231], v[64:67], v[180:183]
    v_mul_f32 v196, v252, v196
    v_mul_f32 v197, v252, v197
    v_mul_f32 v198, v252, v198
    v_mul_f32 v199, v252, v199
    s_waitcnt lgkmcnt(15)
    v_mul_f32 v200, v254, v200
    v_mul_f32 v201, v254, v201
    v_mul_f32 v202, v254, v202
    v_mul_f32 v203, v254, v203
    v_mfma_f32_16x16x32_bf16 v[184:187], v[208:211], v[76:79], v[184:187]
    v_mul_f32 v204, v254, v204
    v_mul_f32 v205, v254, v205
    v_mul_f32 v206, v254, v206
    v_mul_f32 v207, v254, v207
    v_mfma_f32_16x16x32_bf16 v[188:191], v[212:215], v[76:79], v[188:191]
    v_mul_f32 v176, v252, v176
    v_mul_f32 v177, v252, v177
    v_mul_f32 v178, v252, v178
    v_mul_f32 v179, v252, v179
    v_mfma_f32_16x16x32_bf16 v[192:195], v[216:219], v[72:75], v[192:195]
    v_mul_f32 v180, v252, v180
    v_mul_f32 v181, v252, v181
    v_mul_f32 v182, v252, v182
    v_mul_f32 v183, v252, v183
    v_mfma_f32_16x16x32_bf16 v[196:199], v[220:223], v[72:75], v[196:199]
    buffer_load_dwordx4 v[88:91], v25, s[24:27], s85 offen sc1
    buffer_load_dwordx4 v[92:95], v26, s[24:27], s85 offen sc1
    buffer_load_dword v173, v27, s[24:27], s85 offen sc1
    v_add_u32 v21, 0xffff0000, v21
    v_add_u32 v22, 0xffff0000, v22
    v_add_u32 v23, 0xffff0000, v23
    v_add_u32 v24, 0xffff0000, v24
    ds_read_b64_tr_b16 v[144:145], v21 offset:0
    v_mfma_f32_16x16x32_bf16 v[200:203], v[216:219], v[76:79], v[200:203]
    ds_read_b64_tr_b16 v[146:147], v21 offset:2048
    ds_read_b64_tr_b16 v[148:149], v22 offset:0
    ds_read_b64_tr_b16 v[150:151], v22 offset:2048
    ds_read_b64_tr_b16 v[152:153], v23 offset:0
    ds_read_b64_tr_b16 v[154:155], v23 offset:2048
    ds_read_b64_tr_b16 v[156:157], v24 offset:0
    ds_read_b64_tr_b16 v[158:159], v24 offset:2048
    v_mfma_f32_16x16x32_bf16 v[204:207], v[220:223], v[76:79], v[204:207]
    s_waitcnt vmcnt(3)
    v_add3_u32 v248, v172, v80, v81
    v_add3_u32 v249, v82, v83, v84
    v_add3_u32 v248, v248, v85, v86
    v_add3_u32 v248, v248, v249, v87
    v_cmp_ne_u32 vcc, s61, v248
    s_cbranch_vccnz L_slow16
L_back16:
    s_waitcnt lgkmcnt(15)
    v_mfma_f32_16x16x32_bf16 v[184:187], v[112:115], v[84:87], v[184:187]
    buffer_load_dwordx4 v[96:99], v25, s[24:27], s86 offen sc1
    buffer_load_dwordx4 v[100:103], v26, s[24:27], s86 offen sc1
    buffer_load_dword v174, v27, s[24:27], s86 offen sc1
    s_xor_b32 s67, s48, 1
    s_xor_b32 s68, s48, 2
    v_mfma_f32_16x16x32_bf16 v[188:191], v[116:119], v[84:87], v[188:191]
    s_xor_b32 s69, s48, 3
    s_mul_i32 s66, s48, 6144
    s_mul_i32 s67, s67, 6144
    s_mul_i32 s68, s68, 6144
    v_mfma_f32_16x16x32_bf16 v[192:195], v[120:123], v[80:83], v[192:195]
    s_mul_i32 s69, s69, 6144
    v_add_u32 v10, 81920, v2
    v_add_u32 v6, s66, v10
    v_add_u32 v7, s67, v10
    v_add_u32 v8, s68, v10
    v_mfma_f32_16x16x32_bf16 v[196:199], v[124:127], v[80:83], v[196:199]
    v_add_u32 v9, s69, v10
    v_mfma_f32_16x16x32_bf16 v[200:203], v[120:123], v[84:87], v[200:203]
    v_mfma_f32_16x16x32_bf16 v[204:207], v[124:127], v[84:87], v[204:207]
    s_waitcnt vmcnt(3)
    v_add3_u32 v248, v173, v88, v89
    v_add3_u32 v249, v90, v91, v92
    v_add3_u32 v248, v248, v93, v94
    v_add3_u32 v248, v248, v249, v95
    v_cmp_ne_u32 vcc, s61, v248
    s_cbranch_vccnz L_slow17
L_back17:
    s_waitcnt lgkmcnt(8)
    v_mfma_f32_16x16x32_bf16 v[184:187], v[128:131], v[92:95], v[184:187]
    v_mfma_f32_16x16x32_bf16 v[188:191], v[132:135], v[92:95], v[188:191]
    v_mfma_f32_16x16x32_bf16 v[192:195], v[136:139], v[88:91], v[192:195]
    s_barrier
    v_mfma_f32_16x16x32_bf16 v[196:199], v[140:143], v[88:91], v[196:199]
    v_mfma_f32_16x16x32_bf16 v[200:203], v[136:139], v[92:95], v[200:203]
    v_mfma_f32_16x16x32_bf16 v[204:207], v[140:143], v[92:95], v[204:207]
    s_waitcnt vmcnt(0)
    v_add3_u32 v248, v174, v96, v97
    v_add3_u32 v249, v98, v99, v100
    v_add3_u32 v248, v248, v101, v102
    v_add3_u32 v248, v248, v249, v103
    v_cmp_ne_u32 vcc, s61, v248
    s_cbranch_vccnz L_slow18
L_back18:
    s_waitcnt lgkmcnt(0)
    v_mfma_f32_16x16x32_bf16 v[184:187], v[144:147], v[100:103], v[184:187]
    v_mfma_f32_16x16x32_bf16 v[188:191], v[148:151], v[100:103], v[188:191]
    v_mfma_f32_16x16x32_bf16 v[192:195], v[152:155], v[96:99], v[192:195]
    v_mfma_f32_16x16x32_bf16 v[196:199], v[156:159], v[96:99], v[196:199]
    v_mfma_f32_16x16x32_bf16 v[200:203], v[152:155], v[100:103], v[200:203]
    v_mfma_f32_16x16x32_bf16 v[204:207], v[156:159], v[100:103], v[204:207]
    s_nop 2
    ds_write_b128 v7, v[184:187] offset:0
    ds_write_b128 v7, v[188:191] offset:1024
    v_mfma_f32_16x16x32_bf16 v[176:179], v[208:211], v[72:75], v[176:179]
    ds_write_b128 v8, v[192:195] offset:2048
    ds_write_b128 v8, v[196:199] offset:3072
    v_mfma_f32_16x16x32_bf16 v[180:183], v[212:215], v[72:75], v[180:183]
    ds_write_b128 v9, v[200:203] offset:4096
    ds_write_b128 v9, v[204:207] offset:5120
    v_mfma_f32_16x16x32_bf16 v[176:179], v[112:115], v[80:83], v[176:179]
    v_mfma_f32_16x16x32_bf16 v[180:183], v[116:119], v[80:83], v[180:183]
    s_waitcnt lgkmcnt(0)
    s_barrier
    ds_read_b128 v[32:35], v6 offset:0
    ds_read_b128 v[36:39], v6 offset:1024
    ds_read_b128 v[40:43], v6 offset:2048
    ds_read_b128 v[44:47], v6 offset:3072
    ds_read_b128 v[48:51], v6 offset:4096
    ds_read_b128 v[52:55], v6 offset:5120
    v_mfma_f32_16x16x32_bf16 v[176:179], v[128:131], v[88:91], v[176:179]
    v_mfma_f32_16x16x32_bf16 v[180:183], v[132:135], v[88:91], v[180:183]
    v_mfma_f32_16x16x32_bf16 v[176:179], v[144:147], v[96:99], v[176:179]
    v_mfma_f32_16x16x32_bf16 v[180:183], v[148:151], v[96:99], v[180:183]
    s_waitcnt lgkmcnt(3)
    v_pk_add_f32 v[32:33], v[32:33], v[40:41]
    v_pk_add_f32 v[34:35], v[34:35], v[42:43]
    s_waitcnt lgkmcnt(2)
    v_pk_add_f32 v[36:37], v[36:37], v[44:45]
    v_pk_add_f32 v[38:39], v[38:39], v[46:47]
    s_waitcnt lgkmcnt(1)
    v_pk_add_f32 v[32:33], v[32:33], v[48:49]
    v_pk_add_f32 v[34:35], v[34:35], v[50:51]
    s_waitcnt lgkmcnt(0)
    v_pk_add_f32 v[36:37], v[36:37], v[52:53]
    v_pk_add_f32 v[38:39], v[38:39], v[54:55]
    v_pk_add_f32 v[176:177], v[176:177], v[32:33]
    v_pk_add_f32 v[178:179], v[178:179], v[34:35]
    v_pk_add_f32 v[180:181], v[180:181], v[36:37]
    v_pk_add_f32 v[182:183], v[182:183], v[38:39]
    v_cvt_pk_bf16_f32 v240, v176, v177
    v_cvt_pk_bf16_f32 v241, v178, v179
    v_cvt_pk_bf16_f32 v242, v180, v181
    v_cvt_pk_bf16_f32 v243, v182, v183
    s_nop 0
    v_permlane16_swap_b32 v240, v242
    v_permlane16_swap_b32 v241, v243
    buffer_store_dwordx4 v[240:243], v3, s[40:43], s71 offen
    s_endpgm
L_G0:
    s_cmp_lg_u32 s48, 1
    s_cbranch_scc1 L_nocp
    s_getpc_b64 s[66:67]
L_pc:
    s_sub_u32 s66, s66, L_pc-gated_mix__linear_attn_block__dense_activation_gelu__prompt_kernel
    s_subb_u32 s67, s67, 0
    s_lshr_b32 s68, s2, 3
    s_and_b32 s68, s68, 7
    s_lshl_b32 s68, s68, 13
    v_lshl_add_u32 v10, v1, 7, s68
    v_min_u32 v10, L_cend-4-gated_mix__linear_attn_block__dense_activation_gelu__prompt_kernel, v10
    global_load_dword v10, v10, s[66:67]
L_nocp:
    s_load_dwordx2 s[16:17], s[0:1], 40
    s_load_dwordx2 s[20:21], s[0:1], 64
    s_load_dwordx2 s[32:33], s[0:1], 48
    s_load_dwordx2 s[36:37], s[0:1], 16
    s_load_dwordx2 s[44:45], s[0:1], 56
    s_load_dwordx2 s[40:41], s[0:1], 72
    s_or_b32 s71, s2, s48
    s_cmp_lg_u32 s71, 0
    s_cbranch_scc1 L_noclr
    s_mov_b32 s66, 9453568
    s_waitcnt lgkmcnt(0)
    buffer_load_dword v248, off, s[24:27], s66 sc1
    s_waitcnt vmcnt(0)
    v_add_u32 v248, 2, v248
    v_or_b32 v248, 1, v248
    s_mov_b64 exec, 1
    buffer_store_dword v248, off, s[28:31], 0 sc1
    buffer_store_dword v248, off, s[24:27], s66 sc1
    s_mov_b64 exec, -1
    s_nop 7
L_noclr:
    s_cmp_eq_u32 s52, 1
    s_cbranch_scc1 L_G0B
    s_mov_b32 s18, 2752
    s_mov_b32 s19, 0x20000
    s_mov_b32 s34, 1409024
    s_mov_b32 s35, 0x20000
    s_mov_b32 s38, 524288
    s_mov_b32 s39, 0x20000
    s_mov_b32 s46, 1024
    s_mov_b32 s47, 0x20000
    s_mov_b32 s42, 2097152
    s_mov_b32 s43, 0x20000
    s_and_b32 s66, s2, 7
    s_bfe_u32 s58, s2, 0x30004
    s_xor_b32 s67, s58, s52
    s_and_b32 s67, s67, 1
    s_lshr_b32 s68, s2, 7
    s_lshl1_add_u32 s67, s68, s67
    s_lshl2_add_u32 s57, s66, s67
    s_lshr_b32 s67, s58, 1
    s_lshl1_add_u32 s67, s68, s67
    s_and_b32 s67, s67, 3
    s_lshr_b32 s69, s49, 1
    s_lshl1_add_u32 s67, s67, s69
    s_lshl_b32 s83, s67, 12
    s_cmp_eq_u32 s67, 7
    s_cselect_b32 s67, 0, s67
    s_mul_i32 s72, s67, 12288
    v_and_b32 v242, 6, v240
    v_xor_b32 v242, v242, v241
    v_lshlrev_b32 v242, 4, v242
    v_lshl_add_u32 v13, v240, 10, v242
    s_lshl_b32 s66, s58, 7
    s_and_b32 s68, s49, 1
    s_lshl_b32 s68, s68, 15
    s_add_u32 s68, s68, s66
    v_add_u32 v13, s68, v13
    v_add_u32 v14, 0x2000, v13
    v_and_b32 v242, 15, v1
    v_lshrrev_b32 v243, 4, v1
    v_lshlrev_b32 v245, 3, v243
    s_and_b32 s68, s49, 2
    s_lshl_b32 s68, s68, 5
    s_add_u32 s66, s66, s68
    v_add_u32 v28, s66, v245
    v_bfe_u32 v244, v1, 1, 1
    v_and_b32 v245, 3, v240
    v_lshl_add_u32 v244, v245, 1, v244
    v_lshlrev_b32 v244, 4, v244
    v_and_b32 v245, 1, v1
    v_lshl_add_u32 v244, v245, 3, v244
    v_lshrrev_b32 v245, 2, v1
    v_lshl_add_u32 v245, v245, 7, v244
    v_add_u32 v245, s55, v245
    v_xor_b32 v21, s68, v245
    v_xor_b32 v22, 32, v21
    v_xor_b32 v23, 64, v21
    v_xor_b32 v24, 0x60, v21
    s_lshl1_add_u32 s70, s57, 0
    s_mul_i32 s66, s70, 122880
    s_and_b32 s67, s49, 1
    s_lshl_b32 s68, s67, 11
    s_add_u32 s66, s66, s68
    s_lshl_b32 s68, s67, 10
    v_xor_b32 v25, s68, v2
    v_xor_b32 v26, 0x400, v25
    v_add_u32 v25, s66, v25
    v_add_u32 v26, s66, v26
    s_lshr_b32 s66, s70, 3
    s_mul_i32 s66, s66, 122880
    s_and_b32 s70, s70, 7
    s_lshl1_add_u32 s70, s70, s67
    s_lshl_b32 s70, s70, 8
    s_add_u32 s66, s66, s70
    s_add_u32 s66, s66, 7864320
    v_lshl_add_u32 v27, v1, 2, s66
    s_mov_b32 s60, 0x4000
    s_cmp_lt_u32 s49, 3
    s_cselect_b32 s91, s55, 15360
    s_cselect_b32 s92, 1024, 0
    s_mov_b32 s3, 0
    s_add_u32 s73, s72, 24576
    s_sub_u32 s66, s73, 86016
    s_cselect_b32 s73, s73, s66
    s_add_u32 s74, s73, 24576
    s_sub_u32 s66, s74, 86016
    s_cselect_b32 s74, s74, s66
    s_add_u32 s75, s74, 24576
    s_sub_u32 s66, s75, 86016
    s_cselect_b32 s75, s75, s66
    s_add_u32 s76, s75, 24576
    s_sub_u32 s66, s76, 86016
    s_cselect_b32 s76, s76, s66
    s_add_u32 s77, s76, 24576
    s_sub_u32 s66, s77, 86016
    s_cselect_b32 s77, s77, s66
    s_add_u32 s78, s77, 24576
    s_sub_u32 s66, s78, 86016
    s_cselect_b32 s78, s78, s66
    s_add_u32 s79, s78, 24576
    s_sub_u32 s66, s79, 86016
    s_cselect_b32 s79, s79, s66
    s_add_u32 s80, s79, 24576
    s_sub_u32 s66, s80, 86016
    s_cselect_b32 s80, s80, s66
    s_add_u32 s81, s80, 24576
    s_sub_u32 s66, s81, 86016
    s_cselect_b32 s81, s81, s66
    s_add_u32 s82, s81, 24576
    s_sub_u32 s66, s82, 86016
    s_cselect_b32 s82, s82, s66
    s_add_u32 s84, s83, 8192
    s_and_b32 s84, s84, 0x7fff
    s_add_u32 s85, s84, 8192
    s_and_b32 s85, s85, 0x7fff
    s_add_u32 s86, s85, 8192
    s_and_b32 s86, s86, 0x7fff
    s_lshl_b32 s69, s69, 12
    s_add_u32 s75, s75, s69
    s_add_u32 s76, s76, 4096
    s_add_u32 s77, s77, 4096
    s_add_u32 s78, s78, 4096
    s_add_u32 s79, s79, 8192
    s_add_u32 s80, s80, 8192
    s_add_u32 s81, s81, 8192
    s_add_u32 s82, s82, 8192
    s_add_u32 s83, s83, 90112
    s_add_u32 s84, s84, 90112
    s_add_u32 s85, s85, 90112
    s_add_u32 s86, s86, 90112
    s_cmp_ge_u32 s49, 2
    s_cselect_b32 s82, 86016, s82
    s_cmp_eq_u32 s49, 3
    s_cselect_b32 s82, 0x7f200000, s82
    s_lshl2_add_u32 s66, s51, s49
    s_lshl4_add_u32 s67, s66, s50
    s_lshl_b32 s87, s67, 9
    s_add_u32 s87, s87, 8912896
    s_lshl_b32 s88, s67, 6
    s_add_u32 s88, s88, 9175040
    v_lshlrev_b32 v8, 3, v1
    s_lshl_b32 s67, s49, 9
    v_add_u32 v8, s67, v8
    s_lshl_b32 s66, s49, 5
    v_lshl_add_u32 v9, v243, 3, s66
    v_lshrrev_b32 v248, 1, v243
    v_lshl_add_u32 v248, v248, 4, v242
    v_and_b32 v249, 1, v243
    v_lshl_add_u32 v248, v248, 1, v249
    v_lshlrev_b32 v3, 3, v248
    v_lshlrev_b32 v5, 4, v243
    v_lshl_add_u32 v12, v242, 6, v5
    v_lshl_add_u32 v5, v242, 26, v5
    v_lshrrev_b32 v248, 1, v242
    v_lshlrev_b32 v249, 2, v249
    v_xor_b32 v248, v248, v249
    v_and_b32 v249, 1, v242
    v_lshlrev_b32 v249, 4, v249
    v_mov_b32 v250, 0x3f80
    v_lshlrev_b32 v250, v249, v250
    v_cmp_eq_u32 vcc, 0, v248
    s_nop 1
    v_cndmask_b32 v224, 0, v250, vcc
    v_cmp_eq_u32 vcc, 1, v248
    s_nop 1
    v_cndmask_b32 v225, 0, v250, vcc
    v_cmp_eq_u32 vcc, 2, v248
    s_nop 1
    v_cndmask_b32 v226, 0, v250, vcc
    v_cmp_eq_u32 vcc, 3, v248
    s_nop 1
    v_cndmask_b32 v227, 0, v250, vcc
    v_lshrrev_b32 v245, 1, v242
    v_xor_b32 v245, v245, v243
    v_lshlrev_b32 v245, 4, v245
    v_lshl_add_u32 v245, v242, 7, v245
    v_add_u32 v15, 0, v245
    v_xor_b32 v16, 64, v15
    v_bfe_u32 v245, v1, 2, 2
    v_lshl_add_u32 v245, v243, 3, v245
    v_lshl_add_u32 v245, v245, 7, v244
    v_xor_b32 v17, s66, v245
    s_lshr_b32 s69, s2, 3
    s_mul_i32 s66, s2, 5504
    s_lshl_b32 s68, s2, 11
    s_cmp_eq_u32 s49, 1
    s_cselect_b32 s66, s66, 0x7f000000
    s_cmp_eq_u32 s49, 2
    s_cselect_b32 s68, s68, 0x7f000000
    s_movk_i32 s71, 15
    s_mov_b32 s66, 0x7f000000
    s_mov_b32 s68, 0x7f000000
    s_movk_i32 s67, 7
    s_mul_i32 s70, s69, 44032
    s_add_u32 s70, s70, 384
    s_cmp_eq_u32 s49, 0
    s_cselect_b32 s66, s70, s66
    s_cselect_b32 s67, 10, s67
    s_lshl_b32 s70, s69, 14
    s_add_u32 s70, s70, 384
    s_cmp_eq_u32 s49, 3
    s_cselect_b32 s68, s70, s68
    s_cselect_b32 s67, 10, s67
    s_cselect_b32 s71, 15, s71
    v_min_u32 v246, 42, v1
    v_and_b32 v247, s71, v1
    v_lshlrev_b32 v246, s67, v246
    v_lshlrev_b32 v247, s67, v247
    s_mov_b32 s64, 0x3fb8aa3b
    s_mov_b32 s65, 0x3fb8aa3b
    s_mov_b32 s63, 0x358637bd
    v_mov_b32 v6, 0xb5c1a2a0
    v_mov_b32 v7, 0xb5c1a2a0
    v_mov_b32 v208, s63
    v_mov_b32 v209, s63
    v_mov_b32 v210, s63
    v_mov_b32 v211, s63
    v_mov_b32 v212, 0x3f803f80
    v_mov_b32 v213, 0x3f803f80
    v_mov_b32 v214, 0x3f803f80
    v_mov_b32 v215, 0x3f803f80
    s_setprio 1
    s_barrier
    ds_read_b64_tr_b16 v[64:65], v17 offset:16384
    ds_read_b64_tr_b16 v[66:67], v17 offset:16896
    ds_read_b128 v[32:35], v15 offset:0
    ds_read_b64_tr_b16 v[68:69], v17 offset:24576
    ds_read_b64_tr_b16 v[70:71], v17 offset:25088
    ds_read_b128 v[36:39], v15 offset:2048
    ds_read_b128 v[40:43], v15 offset:4096
    ds_read_b128 v[44:47], v15 offset:6144
    ds_read_b128 v[48:51], v15 offset:8192
    ds_read_b128 v[52:55], v15 offset:10240
    ds_read_b128 v[56:59], v15 offset:12288
    ds_read_b128 v[60:63], v15 offset:14336
    s_waitcnt lgkmcnt(0)
    v_mfma_f32_16x16x32_bf16 v[112:115], v[32:35], v[64:67], v[208:211]
    ds_read_b64_tr_b16 v[104:105], v17 offset:20480
    v_mfma_f32_16x16x32_bf16 v[144:147], v[32:35], v[68:71], 0
    ds_read_b64_tr_b16 v[106:107], v17 offset:20992
    v_mfma_f32_16x16x32_bf16 v[116:119], v[36:39], v[64:67], v[208:211]
    ds_read_b128 v[72:75], v16 offset:0
    v_mfma_f32_16x16x32_bf16 v[148:151], v[36:39], v[68:71], 0
    ds_read_b64_tr_b16 v[108:109], v17 offset:28672
    v_mfma_f32_16x16x32_bf16 v[120:123], v[40:43], v[64:67], v[208:211]
    ds_read_b64_tr_b16 v[110:111], v17 offset:29184
    v_mfma_f32_16x16x32_bf16 v[152:155], v[40:43], v[68:71], 0
    ds_read_b128 v[76:79], v16 offset:2048
    v_mfma_f32_16x16x32_bf16 v[124:127], v[44:47], v[64:67], v[208:211]
    ds_read_b128 v[80:83], v16 offset:4096
    v_mfma_f32_16x16x32_bf16 v[156:159], v[44:47], v[68:71], 0
    ds_read_b128 v[84:87], v16 offset:6144
    v_mfma_f32_16x16x32_bf16 v[128:131], v[48:51], v[64:67], v[208:211]
    ds_read_b128 v[88:91], v16 offset:8192
    v_mfma_f32_16x16x32_bf16 v[160:163], v[48:51], v[68:71], 0
    ds_read_b128 v[92:95], v16 offset:10240
    v_mfma_f32_16x16x32_bf16 v[132:135], v[52:55], v[64:67], v[208:211]
    ds_read_b128 v[96:99], v16 offset:12288
    v_mfma_f32_16x16x32_bf16 v[164:167], v[52:55], v[68:71], 0
    ds_read_b128 v[100:103], v16 offset:14336
    v_mfma_f32_16x16x32_bf16 v[136:139], v[56:59], v[64:67], v[208:211]
    v_mfma_f32_16x16x32_bf16 v[168:171], v[56:59], v[68:71], 0
    v_mfma_f32_16x16x32_bf16 v[140:143], v[60:63], v[64:67], v[208:211]
    v_mfma_f32_16x16x32_bf16 v[172:175], v[60:63], v[68:71], 0
    s_barrier
    s_waitcnt lgkmcnt(4)
    v_mfma_f32_16x16x32_bf16 v[112:115], v[72:75], v[104:107], v[112:115]
    ds_read_b64_tr_b16 v[64:65], v17 offset:49152
    v_mfma_f32_16x16x32_bf16 v[144:147], v[72:75], v[108:111], v[144:147]
    ds_read_b64_tr_b16 v[66:67], v17 offset:49664
    v_mfma_f32_16x16x32_bf16 v[116:119], v[76:79], v[104:107], v[116:119]
    ds_read_b128 v[32:35], v15 offset:32768
    v_mfma_f32_16x16x32_bf16 v[148:151], v[76:79], v[108:111], v[148:151]
    ds_read_b64_tr_b16 v[68:69], v17 offset:57344
    v_mfma_f32_16x16x32_bf16 v[120:123], v[80:83], v[104:107], v[120:123]
    ds_read_b64_tr_b16 v[70:71], v17 offset:57856
    v_mfma_f32_16x16x32_bf16 v[152:155], v[80:83], v[108:111], v[152:155]
    ds_read_b128 v[36:39], v15 offset:34816
    v_mfma_f32_16x16x32_bf16 v[124:127], v[84:87], v[104:107], v[124:127]
    ds_read_b128 v[40:43], v15 offset:36864
    v_mfma_f32_16x16x32_bf16 v[156:159], v[84:87], v[108:111], v[156:159]
    ds_read_b128 v[44:47], v15 offset:38912
    s_waitcnt lgkmcnt(8)
    v_mfma_f32_16x16x32_bf16 v[128:131], v[88:91], v[104:107], v[128:131]
    ds_read_b128 v[48:51], v15 offset:40960
    v_mfma_f32_16x16x32_bf16 v[160:163], v[88:91], v[108:111], v[160:163]
    ds_read_b128 v[52:55], v15 offset:43008
    v_mfma_f32_16x16x32_bf16 v[132:135], v[92:95], v[104:107], v[132:135]
    ds_read_b128 v[56:59], v15 offset:45056
    v_mfma_f32_16x16x32_bf16 v[164:167], v[92:95], v[108:111], v[164:167]
    ds_read_b128 v[60:63], v15 offset:47104
    v_mfma_f32_16x16x32_bf16 v[136:139], v[96:99], v[104:107], v[136:139]
    v_mfma_f32_16x16x32_bf16 v[168:171], v[96:99], v[108:111], v[168:171]
    v_mfma_f32_16x16x32_bf16 v[140:143], v[100:103], v[104:107], v[140:143]
    v_mfma_f32_16x16x32_bf16 v[172:175], v[100:103], v[108:111], v[172:175]
    s_waitcnt lgkmcnt(4)
    v_mfma_f32_16x16x32_bf16 v[112:115], v[32:35], v[64:67], v[112:115]
    ds_read_b64_tr_b16 v[104:105], v17 offset:53248
    v_mfma_f32_16x16x32_bf16 v[144:147], v[32:35], v[68:71], v[144:147]
    ds_read_b64_tr_b16 v[106:107], v17 offset:53760
    v_mfma_f32_16x16x32_bf16 v[116:119], v[36:39], v[64:67], v[116:119]
    ds_read_b128 v[72:75], v16 offset:32768
    v_mfma_f32_16x16x32_bf16 v[148:151], v[36:39], v[68:71], v[148:151]
    ds_read_b64_tr_b16 v[108:109], v17 offset:61440
    v_mfma_f32_16x16x32_bf16 v[120:123], v[40:43], v[64:67], v[120:123]
    ds_read_b64_tr_b16 v[110:111], v17 offset:61952
    v_mfma_f32_16x16x32_bf16 v[152:155], v[40:43], v[68:71], v[152:155]
    ds_read_b128 v[76:79], v16 offset:34816
    v_mfma_f32_16x16x32_bf16 v[124:127], v[44:47], v[64:67], v[124:127]
    ds_read_b128 v[80:83], v16 offset:36864
    v_mfma_f32_16x16x32_bf16 v[156:159], v[44:47], v[68:71], v[156:159]
    ds_read_b128 v[84:87], v16 offset:38912
    s_waitcnt lgkmcnt(8)
    v_mfma_f32_16x16x32_bf16 v[128:131], v[48:51], v[64:67], v[128:131]
    ds_read_b128 v[88:91], v16 offset:40960
    v_mfma_f32_16x16x32_bf16 v[160:163], v[48:51], v[68:71], v[160:163]
    ds_read_b128 v[92:95], v16 offset:43008
    v_mfma_f32_16x16x32_bf16 v[132:135], v[52:55], v[64:67], v[132:135]
    ds_read_b128 v[96:99], v16 offset:45056
    v_mfma_f32_16x16x32_bf16 v[164:167], v[52:55], v[68:71], v[164:167]
    ds_read_b128 v[100:103], v16 offset:47104
    v_mfma_f32_16x16x32_bf16 v[136:139], v[56:59], v[64:67], v[136:139]
    v_mfma_f32_16x16x32_bf16 v[168:171], v[56:59], v[68:71], v[168:171]
    v_mfma_f32_16x16x32_bf16 v[140:143], v[60:63], v[64:67], v[140:143]
    v_mfma_f32_16x16x32_bf16 v[172:175], v[60:63], v[68:71], v[172:175]
    s_barrier
    s_waitcnt lgkmcnt(4)
    v_mfma_f32_16x16x32_bf16 v[112:115], v[72:75], v[104:107], v[112:115]
    v_add_u32 v17, 0x10000, v17
    v_add_u32 v15, 0x10000, v15
    v_mfma_f32_16x16x32_bf16 v[144:147], v[72:75], v[108:111], v[144:147]
    v_add_u32 v16, 0x10000, v16
    v_mfma_f32_16x16x32_bf16 v[116:119], v[76:79], v[104:107], v[116:119]
    ds_read_b64_tr_b16 v[64:65], v17 offset:16384
    v_mfma_f32_16x16x32_bf16 v[148:151], v[76:79], v[108:111], v[148:151]
    ds_read_b64_tr_b16 v[66:67], v17 offset:16896
    v_mfma_f32_16x16x32_bf16 v[120:123], v[80:83], v[104:107], v[120:123]
    ds_read_b128 v[32:35], v15 offset:0
    ds_read_b64_tr_b16 v[68:69], v17 offset:24576
    v_mfma_f32_16x16x32_bf16 v[152:155], v[80:83], v[108:111], v[152:155]
    ds_read_b64_tr_b16 v[70:71], v17 offset:25088
    v_mfma_f32_16x16x32_bf16 v[124:127], v[84:87], v[104:107], v[124:127]
    ds_read_b128 v[36:39], v15 offset:2048
    v_mfma_f32_16x16x32_bf16 v[156:159], v[84:87], v[108:111], v[156:159]
    ds_read_b128 v[40:43], v15 offset:4096
    s_waitcnt lgkmcnt(7)
    v_mfma_f32_16x16x32_bf16 v[128:131], v[88:91], v[104:107], v[128:131]
    ds_read_b128 v[44:47], v15 offset:6144
    ds_read_b128 v[48:51], v15 offset:8192
    v_mfma_f32_16x16x32_bf16 v[160:163], v[88:91], v[108:111], v[160:163]
    ds_read_b128 v[52:55], v15 offset:10240
    v_mfma_f32_16x16x32_bf16 v[132:135], v[92:95], v[104:107], v[132:135]
    ds_read_b128 v[56:59], v15 offset:12288
    v_mfma_f32_16x16x32_bf16 v[164:167], v[92:95], v[108:111], v[164:167]
    ds_read_b128 v[60:63], v15 offset:14336
    v_mfma_f32_16x16x32_bf16 v[136:139], v[96:99], v[104:107], v[136:139]
    v_mfma_f32_16x16x32_bf16 v[168:171], v[96:99], v[108:111], v[168:171]
    v_mfma_f32_16x16x32_bf16 v[140:143], v[100:103], v[104:107], v[140:143]
    v_mfma_f32_16x16x32_bf16 v[172:175], v[100:103], v[108:111], v[172:175]
    s_waitcnt lgkmcnt(4)
    v_mfma_f32_16x16x32_bf16 v[112:115], v[32:35], v[64:67], v[112:115]
    ds_read_b64_tr_b16 v[104:105], v17 offset:20480
    ds_read_b64_tr_b16 v[106:107], v17 offset:20992
    v_mfma_f32_16x16x32_bf16 v[144:147], v[32:35], v[68:71], v[144:147]
    ds_read_b128 v[72:75], v16 offset:0
    v_mfma_f32_16x16x32_bf16 v[116:119], v[36:39], v[64:67], v[116:119]
    ds_read_b64_tr_b16 v[108:109], v17 offset:28672
    v_mfma_f32_16x16x32_bf16 v[148:151], v[36:39], v[68:71], v[148:151]
    ds_read_b64_tr_b16 v[110:111], v17 offset:29184
    v_mfma_f32_16x16x32_bf16 v[120:123], v[40:43], v[64:67], v[120:123]
    ds_read_b128 v[76:79], v16 offset:2048
    v_mfma_f32_16x16x32_bf16 v[152:155], v[40:43], v[68:71], v[152:155]
    ds_read_b128 v[80:83], v16 offset:4096
    v_mfma_f32_16x16x32_bf16 v[124:127], v[44:47], v[64:67], v[124:127]
    ds_read_b128 v[84:87], v16 offset:6144
    ds_read_b128 v[88:91], v16 offset:8192
    v_mfma_f32_16x16x32_bf16 v[156:159], v[44:47], v[68:71], v[156:159]
    ds_read_b128 v[92:95], v16 offset:10240
    s_waitcnt lgkmcnt(10)
    v_mfma_f32_16x16x32_bf16 v[128:131], v[48:51], v[64:67], v[128:131]
    ds_read_b128 v[96:99], v16 offset:12288
    v_mfma_f32_16x16x32_bf16 v[160:163], v[48:51], v[68:71], v[160:163]
    ds_read_b128 v[100:103], v16 offset:14336
    v_mfma_f32_16x16x32_bf16 v[132:135], v[52:55], v[64:67], v[132:135]
    buffer_load_dwordx2 v[30:31], v28, s[44:47], 0 offen offset:32
    v_mfma_f32_16x16x32_bf16 v[164:167], v[52:55], v[68:71], v[164:167]
    buffer_load_dwordx2 v[28:29], v28, s[44:47], 0 offen
    v_mfma_f32_16x16x32_bf16 v[136:139], v[56:59], v[64:67], v[136:139]
    v_mfma_f32_16x16x32_bf16 v[168:171], v[56:59], v[68:71], v[168:171]
    v_mfma_f32_16x16x32_bf16 v[140:143], v[60:63], v[64:67], v[140:143]
    v_mfma_f32_16x16x32_bf16 v[172:175], v[60:63], v[68:71], v[172:175]
    s_barrier
    s_waitcnt lgkmcnt(4)
    v_mfma_f32_16x16x32_bf16 v[112:115], v[72:75], v[104:107], v[112:115]
    ds_read_b64_tr_b16 v[64:65], v17 offset:49152
    v_mfma_f32_16x16x32_bf16 v[144:147], v[72:75], v[108:111], v[144:147]
    ds_read_b64_tr_b16 v[66:67], v17 offset:49664
    v_mfma_f32_16x16x32_bf16 v[116:119], v[76:79], v[104:107], v[116:119]
    ds_read_b128 v[32:35], v15 offset:32768
    v_mfma_f32_16x16x32_bf16 v[148:151], v[76:79], v[108:111], v[148:151]
    ds_read_b64_tr_b16 v[68:69], v17 offset:57344
    v_mfma_f32_16x16x32_bf16 v[120:123], v[80:83], v[104:107], v[120:123]
    ds_read_b64_tr_b16 v[70:71], v17 offset:57856
    v_mfma_f32_16x16x32_bf16 v[152:155], v[80:83], v[108:111], v[152:155]
    ds_read_b128 v[36:39], v15 offset:34816
    v_mfma_f32_16x16x32_bf16 v[124:127], v[84:87], v[104:107], v[124:127]
    ds_read_b128 v[40:43], v15 offset:36864
    v_mfma_f32_16x16x32_bf16 v[156:159], v[84:87], v[108:111], v[156:159]
    ds_read_b128 v[44:47], v15 offset:38912
    s_waitcnt lgkmcnt(8)
    v_mfma_f32_16x16x32_bf16 v[128:131], v[88:91], v[104:107], v[128:131]
    ds_read_b128 v[48:51], v15 offset:40960
    v_mfma_f32_16x16x32_bf16 v[160:163], v[88:91], v[108:111], v[160:163]
    ds_read_b128 v[52:55], v15 offset:43008
    v_mfma_f32_16x16x32_bf16 v[132:135], v[92:95], v[104:107], v[132:135]
    ds_read_b128 v[56:59], v15 offset:45056
    v_mfma_f32_16x16x32_bf16 v[164:167], v[92:95], v[108:111], v[164:167]
    ds_read_b128 v[60:63], v15 offset:47104
    v_mfma_f32_16x16x32_bf16 v[136:139], v[96:99], v[104:107], v[136:139]
    v_mfma_f32_16x16x32_bf16 v[168:171], v[96:99], v[108:111], v[168:171]
    v_mfma_f32_16x16x32_bf16 v[140:143], v[100:103], v[104:107], v[140:143]
    v_mfma_f32_16x16x32_bf16 v[172:175], v[100:103], v[108:111], v[172:175]
    s_waitcnt lgkmcnt(4)
    v_mfma_f32_16x16x32_bf16 v[112:115], v[32:35], v[64:67], v[112:115]
    ds_read_b64_tr_b16 v[104:105], v17 offset:53248
    v_mfma_f32_16x16x32_bf16 v[144:147], v[32:35], v[68:71], v[144:147]
    ds_read_b64_tr_b16 v[106:107], v17 offset:53760
    v_mfma_f32_16x16x32_bf16 v[116:119], v[36:39], v[64:67], v[116:119]
    ds_read_b128 v[72:75], v16 offset:32768
    v_mfma_f32_16x16x32_bf16 v[148:151], v[36:39], v[68:71], v[148:151]
    ds_read_b64_tr_b16 v[108:109], v17 offset:61440
    v_mfma_f32_16x16x32_bf16 v[120:123], v[40:43], v[64:67], v[120:123]
    ds_read_b64_tr_b16 v[110:111], v17 offset:61952
    v_mfma_f32_16x16x32_bf16 v[152:155], v[40:43], v[68:71], v[152:155]
    ds_read_b128 v[76:79], v16 offset:34816
    v_mfma_f32_16x16x32_bf16 v[124:127], v[44:47], v[64:67], v[124:127]
    ds_read_b128 v[80:83], v16 offset:36864
    v_mfma_f32_16x16x32_bf16 v[156:159], v[44:47], v[68:71], v[156:159]
    ds_read_b128 v[84:87], v16 offset:38912
    s_waitcnt lgkmcnt(8)
    v_mfma_f32_16x16x32_bf16 v[128:131], v[48:51], v[64:67], v[128:131]
    ds_read_b128 v[88:91], v16 offset:40960
    v_mfma_f32_16x16x32_bf16 v[160:163], v[48:51], v[68:71], v[160:163]
    ds_read_b128 v[92:95], v16 offset:43008
    v_mfma_f32_16x16x32_bf16 v[132:135], v[52:55], v[64:67], v[132:135]
    ds_read_b128 v[96:99], v16 offset:45056
    v_mfma_f32_16x16x32_bf16 v[164:167], v[52:55], v[68:71], v[164:167]
    ds_read_b128 v[100:103], v16 offset:47104
    v_mfma_f32_16x16x32_bf16 v[136:139], v[56:59], v[64:67], v[136:139]
    v_mfma_f32_16x16x32_bf16 v[168:171], v[56:59], v[68:71], v[168:171]
    v_mfma_f32_16x16x32_bf16 v[140:143], v[60:63], v[64:67], v[140:143]
    v_mfma_f32_16x16x32_bf16 v[172:175], v[60:63], v[68:71], v[172:175]
    s_barrier
    s_waitcnt lgkmcnt(4)
    v_mfma_f32_16x16x32_bf16 v[112:115], v[72:75], v[104:107], v[112:115]
    v_add_u32 v17, 0x10000, v17
    v_add_u32 v15, 0x10000, v15
    v_mfma_f32_16x16x32_bf16 v[144:147], v[72:75], v[108:111], v[144:147]
    v_add_u32 v16, 0x10000, v16
    v_mfma_f32_16x16x32_bf16 v[116:119], v[76:79], v[104:107], v[116:119]
    ds_read_b64_tr_b16 v[64:65], v17 offset:16384
    v_mfma_f32_16x16x32_bf16 v[148:151], v[76:79], v[108:111], v[148:151]
    ds_read_b64_tr_b16 v[66:67], v17 offset:16896
    v_mfma_f32_16x16x32_bf16 v[120:123], v[80:83], v[104:107], v[120:123]
    ds_read_b128 v[32:35], v15 offset:0
    ds_read_b64_tr_b16 v[68:69], v17 offset:24576
    v_mfma_f32_16x16x32_bf16 v[152:155], v[80:83], v[108:111], v[152:155]
    ds_read_b64_tr_b16 v[70:71], v17 offset:25088
    v_mfma_f32_16x16x32_bf16 v[124:127], v[84:87], v[104:107], v[124:127]
    ds_read_b128 v[36:39], v15 offset:2048
    v_mfma_f32_16x16x32_bf16 v[156:159], v[84:87], v[108:111], v[156:159]
    ds_read_b128 v[40:43], v15 offset:4096
    s_waitcnt lgkmcnt(7)
    v_mfma_f32_16x16x32_bf16 v[128:131], v[88:91], v[104:107], v[128:131]
    ds_read_b128 v[44:47], v15 offset:6144
    ds_read_b128 v[48:51], v15 offset:8192
    v_mfma_f32_16x16x32_bf16 v[160:163], v[88:91], v[108:111], v[160:163]
    ds_read_b128 v[52:55], v15 offset:10240
    v_mfma_f32_16x16x32_bf16 v[132:135], v[92:95], v[104:107], v[132:135]
    ds_read_b128 v[56:59], v15 offset:12288
    v_mfma_f32_16x16x32_bf16 v[164:167], v[92:95], v[108:111], v[164:167]
    ds_read_b128 v[60:63], v15 offset:14336
    v_mfma_f32_16x16x32_bf16 v[136:139], v[96:99], v[104:107], v[136:139]
    v_mfma_f32_16x16x32_bf16 v[168:171], v[96:99], v[108:111], v[168:171]
    v_mfma_f32_16x16x32_bf16 v[140:143], v[100:103], v[104:107], v[140:143]
    v_mfma_f32_16x16x32_bf16 v[172:175], v[100:103], v[108:111], v[172:175]
    s_waitcnt lgkmcnt(4)
    v_mfma_f32_16x16x32_bf16 v[112:115], v[32:35], v[64:67], v[112:115]
    ds_read_b64_tr_b16 v[104:105], v17 offset:20480
    ds_read_b64_tr_b16 v[106:107], v17 offset:20992
    v_mfma_f32_16x16x32_bf16 v[144:147], v[32:35], v[68:71], v[144:147]
    ds_read_b128 v[72:75], v16 offset:0
    v_mfma_f32_16x16x32_bf16 v[116:119], v[36:39], v[64:67], v[116:119]
    ds_read_b64_tr_b16 v[108:109], v17 offset:28672
    v_mfma_f32_16x16x32_bf16 v[148:151], v[36:39], v[68:71], v[148:151]
    ds_read_b64_tr_b16 v[110:111], v17 offset:29184
    v_mfma_f32_16x16x32_bf16 v[120:123], v[40:43], v[64:67], v[120:123]
    ds_read_b128 v[76:79], v16 offset:2048
    v_mfma_f32_16x16x32_bf16 v[152:155], v[40:43], v[68:71], v[152:155]
    ds_read_b128 v[80:83], v16 offset:4096
    v_mfma_f32_16x16x32_bf16 v[124:127], v[44:47], v[64:67], v[124:127]
    ds_read_b128 v[84:87], v16 offset:6144
    v_mfma_f32_16x16x32_bf16 v[156:159], v[44:47], v[68:71], v[156:159]
    ds_read_b128 v[88:91], v16 offset:8192
    s_waitcnt lgkmcnt(9)
    v_mfma_f32_16x16x32_bf16 v[128:131], v[48:51], v[64:67], v[128:131]
    ds_read_b128 v[92:95], v16 offset:10240
    v_mfma_f32_16x16x32_bf16 v[160:163], v[48:51], v[68:71], v[160:163]
    ds_read_b128 v[96:99], v16 offset:12288
    v_mfma_f32_16x16x32_bf16 v[132:135], v[52:55], v[64:67], v[132:135]
    ds_read_b128 v[100:103], v16 offset:14336
    v_mfma_f32_16x16x32_bf16 v[164:167], v[52:55], v[68:71], v[164:167]
    buffer_load_dword v4, off, s[28:31], 0 sc1
    v_mfma_f32_16x16x32_bf16 v[136:139], v[56:59], v[64:67], v[136:139]
    v_mfma_f32_16x16x32_bf16 v[168:171], v[56:59], v[68:71], v[168:171]
    v_mfma_f32_16x16x32_bf16 v[140:143], v[60:63], v[64:67], v[140:143]
    v_mfma_f32_16x16x32_bf16 v[172:175], v[60:63], v[68:71], v[172:175]
    s_barrier
    s_waitcnt lgkmcnt(4)
    v_mfma_f32_16x16x32_bf16 v[112:115], v[72:75], v[104:107], v[112:115]
    v_add_u32 v17, 0xfffe0000, v17
    v_add_u32 v15, 0xfffe0000, v15
    v_mfma_f32_16x16x32_bf16 v[144:147], v[72:75], v[108:111], v[144:147]
    v_add_u32 v16, 0xfffe0000, v16
    v_mfma_f32_16x16x32_bf16 v[116:119], v[76:79], v[104:107], v[116:119]
    ds_read_b64_tr_b16 v[64:65], v17 offset:16384
    v_mfma_f32_16x16x32_bf16 v[148:151], v[76:79], v[108:111], v[148:151]
    ds_read_b64_tr_b16 v[66:67], v17 offset:16896
    v_mfma_f32_16x16x32_bf16 v[120:123], v[80:83], v[104:107], v[120:123]
    ds_read_b128 v[32:35], v15 offset:0
    ds_read_b64_tr_b16 v[68:69], v17 offset:24576
    v_mfma_f32_16x16x32_bf16 v[152:155], v[80:83], v[108:111], v[152:155]
    ds_read_b64_tr_b16 v[70:71], v17 offset:25088
    v_mfma_f32_16x16x32_bf16 v[124:127], v[84:87], v[104:107], v[124:127]
    ds_read_b128 v[36:39], v15 offset:2048
    v_mfma_f32_16x16x32_bf16 v[156:159], v[84:87], v[108:111], v[156:159]
    ds_read_b128 v[40:43], v15 offset:4096
    s_waitcnt lgkmcnt(7)
    v_mfma_f32_16x16x32_bf16 v[128:131], v[88:91], v[104:107], v[128:131]
    ds_read_b128 v[44:47], v15 offset:6144
    ds_read_b128 v[48:51], v15 offset:8192
    v_mfma_f32_16x16x32_bf16 v[160:163], v[88:91], v[108:111], v[160:163]
    ds_read_b128 v[52:55], v15 offset:10240
    v_mfma_f32_16x16x32_bf16 v[132:135], v[92:95], v[104:107], v[132:135]
    ds_read_b128 v[56:59], v15 offset:12288
    v_mfma_f32_16x16x32_bf16 v[164:167], v[92:95], v[108:111], v[164:167]
    ds_read_b128 v[60:63], v15 offset:14336
    v_mfma_f32_16x16x32_bf16 v[136:139], v[96:99], v[104:107], v[136:139]
    v_mfma_f32_16x16x32_bf16 v[168:171], v[96:99], v[108:111], v[168:171]
    v_mfma_f32_16x16x32_bf16 v[140:143], v[100:103], v[104:107], v[140:143]
    v_mfma_f32_16x16x32_bf16 v[172:175], v[100:103], v[108:111], v[172:175]
    s_waitcnt lgkmcnt(4)
    v_mfma_f32_16x16x32_bf16 v[112:115], v[32:35], v[64:67], v[112:115]
    ds_read_b64_tr_b16 v[104:105], v17 offset:20480
    v_mfma_f32_16x16x32_bf16 v[144:147], v[32:35], v[68:71], v[144:147]
    ds_read_b64_tr_b16 v[106:107], v17 offset:20992
    v_mfma_f32_16x16x32_bf16 v[116:119], v[36:39], v[64:67], v[116:119]
    ds_read_b128 v[72:75], v16 offset:0
    v_mfma_f32_16x16x32_bf16 v[148:151], v[36:39], v[68:71], v[148:151]
    ds_read_b64_tr_b16 v[108:109], v17 offset:28672
    v_mfma_f32_16x16x32_bf16 v[120:123], v[40:43], v[64:67], v[120:123]
    ds_read_b64_tr_b16 v[110:111], v17 offset:29184
    v_mfma_f32_16x16x32_bf16 v[152:155], v[40:43], v[68:71], v[152:155]
    ds_read_b128 v[76:79], v16 offset:2048
    v_mfma_f32_16x16x32_bf16 v[124:127], v[44:47], v[64:67], v[124:127]
    ds_read_b128 v[80:83], v16 offset:4096
    v_mfma_f32_16x16x32_bf16 v[156:159], v[44:47], v[68:71], v[156:159]
    ds_read_b128 v[84:87], v16 offset:6144
    s_waitcnt lgkmcnt(8)
    v_mfma_f32_16x16x32_bf16 v[128:131], v[48:51], v[64:67], v[128:131]
    ds_read_b128 v[88:91], v16 offset:8192
    v_mfma_f32_16x16x32_bf16 v[160:163], v[48:51], v[68:71], v[160:163]
    ds_read_b128 v[92:95], v16 offset:10240
    v_mfma_f32_16x16x32_bf16 v[132:135], v[52:55], v[64:67], v[132:135]
    ds_read_b128 v[96:99], v16 offset:12288
    v_mfma_f32_16x16x32_bf16 v[164:167], v[52:55], v[68:71], v[164:167]
    ds_read_b128 v[100:103], v16 offset:14336
    v_mfma_f32_16x16x32_bf16 v[136:139], v[56:59], v[64:67], v[136:139]
    v_mfma_f32_16x16x32_bf16 v[168:171], v[56:59], v[68:71], v[168:171]
    v_mfma_f32_16x16x32_bf16 v[140:143], v[60:63], v[64:67], v[140:143]
    v_mfma_f32_16x16x32_bf16 v[172:175], v[60:63], v[68:71], v[172:175]
    s_barrier
    s_waitcnt lgkmcnt(4)
    v_mfma_f32_16x16x32_bf16 v[112:115], v[72:75], v[104:107], v[112:115]
    ds_read_b64_tr_b16 v[64:65], v17 offset:49152
    v_mfma_f32_16x16x32_bf16 v[144:147], v[72:75], v[108:111], v[144:147]
    ds_read_b64_tr_b16 v[66:67], v17 offset:49664
    v_mfma_f32_16x16x32_bf16 v[116:119], v[76:79], v[104:107], v[116:119]
    ds_read_b128 v[32:35], v15 offset:32768
    v_mfma_f32_16x16x32_bf16 v[148:151], v[76:79], v[108:111], v[148:151]
    ds_read_b64_tr_b16 v[68:69], v17 offset:57344
    v_mfma_f32_16x16x32_bf16 v[120:123], v[80:83], v[104:107], v[120:123]
    ds_read_b64_tr_b16 v[70:71], v17 offset:57856
    v_mfma_f32_16x16x32_bf16 v[152:155], v[80:83], v[108:111], v[152:155]
    ds_read_b128 v[36:39], v15 offset:34816
    v_mfma_f32_16x16x32_bf16 v[124:127], v[84:87], v[104:107], v[124:127]
    ds_read_b128 v[40:43], v15 offset:36864
    v_mfma_f32_16x16x32_bf16 v[156:159], v[84:87], v[108:111], v[156:159]
    ds_read_b128 v[44:47], v15 offset:38912
    s_waitcnt lgkmcnt(8)
    v_mfma_f32_16x16x32_bf16 v[128:131], v[88:91], v[104:107], v[128:131]
    ds_read_b128 v[48:51], v15 offset:40960
    v_mfma_f32_16x16x32_bf16 v[160:163], v[88:91], v[108:111], v[160:163]
    ds_read_b128 v[52:55], v15 offset:43008
    v_mfma_f32_16x16x32_bf16 v[132:135], v[92:95], v[104:107], v[132:135]
    ds_read_b128 v[56:59], v15 offset:45056
    v_mfma_f32_16x16x32_bf16 v[164:167], v[92:95], v[108:111], v[164:167]
    ds_read_b128 v[60:63], v15 offset:47104
    v_mfma_f32_16x16x32_bf16 v[136:139], v[96:99], v[104:107], v[136:139]
    v_mfma_f32_16x16x32_bf16 v[168:171], v[96:99], v[108:111], v[168:171]
    v_mfma_f32_16x16x32_bf16 v[140:143], v[100:103], v[104:107], v[140:143]
    v_mfma_f32_16x16x32_bf16 v[172:175], v[100:103], v[108:111], v[172:175]
    s_waitcnt lgkmcnt(4)
    v_mfma_f32_16x16x32_bf16 v[112:115], v[32:35], v[64:67], v[112:115]
    ds_read_b64_tr_b16 v[104:105], v17 offset:53248
    ds_read_b64_tr_b16 v[106:107], v17 offset:53760
    v_mfma_f32_16x16x32_bf16 v[144:147], v[32:35], v[68:71], v[144:147]
    ds_read_b128 v[72:75], v16 offset:32768
    v_mfma_f32_16x16x32_bf16 v[116:119], v[36:39], v[64:67], v[116:119]
    ds_read_b64_tr_b16 v[108:109], v17 offset:61440
    v_mfma_f32_16x16x32_bf16 v[148:151], v[36:39], v[68:71], v[148:151]
    ds_read_b64_tr_b16 v[110:111], v17 offset:61952
    v_mfma_f32_16x16x32_bf16 v[120:123], v[40:43], v[64:67], v[120:123]
    ds_read_b128 v[76:79], v16 offset:34816
    v_mfma_f32_16x16x32_bf16 v[152:155], v[40:43], v[68:71], v[152:155]
    ds_read_b128 v[80:83], v16 offset:36864
    v_mfma_f32_16x16x32_bf16 v[124:127], v[44:47], v[64:67], v[124:127]
    ds_read_b128 v[84:87], v16 offset:38912
    ds_read_b128 v[88:91], v16 offset:40960
    v_mfma_f32_16x16x32_bf16 v[156:159], v[44:47], v[68:71], v[156:159]
    ds_read_b128 v[92:95], v16 offset:43008
    s_waitcnt lgkmcnt(10)
    v_mfma_f32_16x16x32_bf16 v[128:131], v[48:51], v[64:67], v[128:131]
    ds_read_b128 v[96:99], v16 offset:45056
    v_mfma_f32_16x16x32_bf16 v[160:163], v[48:51], v[68:71], v[160:163]
    ds_read_b128 v[100:103], v16 offset:47104
    v_mfma_f32_16x16x32_bf16 v[132:135], v[52:55], v[64:67], v[132:135]
    buffer_load_dword v10, v246, s[32:35], s66 offen
    v_mfma_f32_16x16x32_bf16 v[164:167], v[52:55], v[68:71], v[164:167]
    buffer_load_dword v11, v247, s[36:39], s68 offen
    v_mfma_f32_16x16x32_bf16 v[136:139], v[56:59], v[64:67], v[136:139]
    v_mfma_f32_16x16x32_bf16 v[168:171], v[56:59], v[68:71], v[168:171]
    v_mfma_f32_16x16x32_bf16 v[140:143], v[60:63], v[64:67], v[140:143]
    v_mfma_f32_16x16x32_bf16 v[172:175], v[60:63], v[68:71], v[172:175]
    s_barrier
    s_waitcnt lgkmcnt(4)
    v_mfma_f32_16x16x32_bf16 v[112:115], v[72:75], v[104:107], v[112:115]
    v_add_u32 v17, 0x10000, v17
    v_add_u32 v15, 0x10000, v15
    v_mfma_f32_16x16x32_bf16 v[144:147], v[72:75], v[108:111], v[144:147]
    v_add_u32 v16, 0x10000, v16
    v_mfma_f32_16x16x32_bf16 v[116:119], v[76:79], v[104:107], v[116:119]
    ds_read_b64_tr_b16 v[64:65], v17 offset:16384
    v_mfma_f32_16x16x32_bf16 v[148:151], v[76:79], v[108:111], v[148:151]
    ds_read_b64_tr_b16 v[66:67], v17 offset:16896
    v_mfma_f32_16x16x32_bf16 v[120:123], v[80:83], v[104:107], v[120:123]
    ds_read_b128 v[32:35], v15 offset:0
    ds_read_b64_tr_b16 v[68:69], v17 offset:24576
    v_mfma_f32_16x16x32_bf16 v[152:155], v[80:83], v[108:111], v[152:155]
    ds_read_b64_tr_b16 v[70:71], v17 offset:25088
    v_mfma_f32_16x16x32_bf16 v[124:127], v[84:87], v[104:107], v[124:127]
    ds_read_b128 v[36:39], v15 offset:2048
    v_mfma_f32_16x16x32_bf16 v[156:159], v[84:87], v[108:111], v[156:159]
    ds_read_b128 v[40:43], v15 offset:4096
    s_waitcnt lgkmcnt(7)
    v_mfma_f32_16x16x32_bf16 v[128:131], v[88:91], v[104:107], v[128:131]
    ds_read_b128 v[44:47], v15 offset:6144
    ds_read_b128 v[48:51], v15 offset:8192
    v_mfma_f32_16x16x32_bf16 v[160:163], v[88:91], v[108:111], v[160:163]
    ds_read_b128 v[52:55], v15 offset:10240
    v_mfma_f32_16x16x32_bf16 v[132:135], v[92:95], v[104:107], v[132:135]
    ds_read_b128 v[56:59], v15 offset:12288
    v_mfma_f32_16x16x32_bf16 v[164:167], v[92:95], v[108:111], v[164:167]
    ds_read_b128 v[60:63], v15 offset:14336
    v_mfma_f32_16x16x32_bf16 v[136:139], v[96:99], v[104:107], v[136:139]
    v_mfma_f32_16x16x32_bf16 v[168:171], v[96:99], v[108:111], v[168:171]
    v_mfma_f32_16x16x32_bf16 v[140:143], v[100:103], v[104:107], v[140:143]
    v_mfma_f32_16x16x32_bf16 v[172:175], v[100:103], v[108:111], v[172:175]
    s_waitcnt lgkmcnt(4)
    v_mfma_f32_16x16x32_bf16 v[112:115], v[32:35], v[64:67], v[112:115]
    ds_read_b64_tr_b16 v[104:105], v17 offset:20480
    v_mfma_f32_16x16x32_bf16 v[144:147], v[32:35], v[68:71], v[144:147]
    ds_read_b64_tr_b16 v[106:107], v17 offset:20992
    v_mfma_f32_16x16x32_bf16 v[116:119], v[36:39], v[64:67], v[116:119]
    ds_read_b128 v[72:75], v16 offset:0
    v_mfma_f32_16x16x32_bf16 v[148:151], v[36:39], v[68:71], v[148:151]
    ds_read_b64_tr_b16 v[108:109], v17 offset:28672
    v_mfma_f32_16x16x32_bf16 v[120:123], v[40:43], v[64:67], v[120:123]
    ds_read_b64_tr_b16 v[110:111], v17 offset:29184
    v_mfma_f32_16x16x32_bf16 v[152:155], v[40:43], v[68:71], v[152:155]
    ds_read_b128 v[76:79], v16 offset:2048
    v_mfma_f32_16x16x32_bf16 v[124:127], v[44:47], v[64:67], v[124:127]
    ds_read_b128 v[80:83], v16 offset:4096
    v_mfma_f32_16x16x32_bf16 v[156:159], v[44:47], v[68:71], v[156:159]
    ds_read_b128 v[84:87], v16 offset:6144
    s_waitcnt lgkmcnt(8)
    v_mfma_f32_16x16x32_bf16 v[128:131], v[48:51], v[64:67], v[128:131]
    ds_read_b128 v[88:91], v16 offset:8192
    v_mfma_f32_16x16x32_bf16 v[160:163], v[48:51], v[68:71], v[160:163]
    ds_read_b128 v[92:95], v16 offset:10240
    v_mfma_f32_16x16x32_bf16 v[132:135], v[52:55], v[64:67], v[132:135]
    ds_read_b128 v[96:99], v16 offset:12288
    v_mfma_f32_16x16x32_bf16 v[164:167], v[52:55], v[68:71], v[164:167]
    ds_read_b128 v[100:103], v16 offset:14336
    v_mfma_f32_16x16x32_bf16 v[136:139], v[56:59], v[64:67], v[136:139]
    v_mfma_f32_16x16x32_bf16 v[168:171], v[56:59], v[68:71], v[168:171]
    v_mfma_f32_16x16x32_bf16 v[140:143], v[60:63], v[64:67], v[140:143]
    v_mfma_f32_16x16x32_bf16 v[172:175], v[60:63], v[68:71], v[172:175]
    s_barrier
    s_waitcnt lgkmcnt(4)
    v_mfma_f32_16x16x32_bf16 v[112:115], v[72:75], v[104:107], v[112:115]
    v_mfma_f32_16x16x32_bf16 v[144:147], v[72:75], v[108:111], v[144:147]
    v_mfma_f32_16x16x32_bf16 v[116:119], v[76:79], v[104:107], v[116:119]
    v_mfma_f32_16x16x32_bf16 v[148:151], v[76:79], v[108:111], v[148:151]
    v_mfma_f32_16x16x32_bf16 v[120:123], v[80:83], v[104:107], v[120:123]
    v_mfma_f32_16x16x32_bf16 v[152:155], v[80:83], v[108:111], v[152:155]
    v_mfma_f32_16x16x32_bf16 v[124:127], v[84:87], v[104:107], v[124:127]
    v_mfma_f32_16x16x32_bf16 v[156:159], v[84:87], v[108:111], v[156:159]
    s_waitcnt lgkmcnt(0)
    v_mfma_f32_16x16x32_bf16 v[128:131], v[88:91], v[104:107], v[128:131]
    v_mfma_f32_16x16x32_bf16 v[160:163], v[88:91], v[108:111], v[160:163]
    v_mfma_f32_16x16x32_bf16 v[132:135], v[92:95], v[104:107], v[132:135]
    v_mfma_f32_16x16x32_bf16 v[164:167], v[92:95], v[108:111], v[164:167]
    v_mfma_f32_16x16x32_bf16 v[136:139], v[96:99], v[104:107], v[136:139]
    v_mfma_f32_16x16x32_bf16 v[168:171], v[96:99], v[108:111], v[168:171]
    v_mfma_f32_16x16x32_bf16 v[140:143], v[100:103], v[104:107], v[140:143]
    v_mfma_f32_16x16x32_bf16 v[172:175], v[100:103], v[108:111], v[172:175]
    s_setprio 0
    s_waitcnt vmcnt(2)
    v_cmp_eq_u32 vcc, 0, v4
    s_cbranch_vccnz L_slow19
L_back19:
    v_readfirstlane_b32 s61, v4
    s_cmp_eq_u32 s49, 3
    s_cselect_b32 s23, 0, s61
    s_lshl_b32 s62, s61, 1
    v_fma_f32 v240, v112, s64, v6
    v_fma_f32 v241, v113, s64, v6
    v_fma_f32 v242, v114, s64, v6
    v_fma_f32 v243, v115, s64, v6
    v_fma_f32 v244, v116, s64, v6
    v_fma_f32 v245, v117, s64, v6
    v_fma_f32 v246, v118, s64, v6
    v_fma_f32 v247, v119, s64, v6
    v_fma_f32 v248, v120, s64, v6
    v_fma_f32 v249, v121, s64, v6
    v_fma_f32 v250, v122, s64, v6
    v_fma_f32 v251, v123, s64, v6
    v_fma_f32 v252, v124, s64, v6
    v_fma_f32 v253, v125, s64, v6
    v_fma_f32 v254, v126, s64, v6
    v_fma_f32 v255, v127, s64, v6
    v_exp_f32_e64 v240, v240 clamp
    v_exp_f32_e64 v241, v241 clamp
    v_exp_f32_e64 v242, v242 clamp
    v_exp_f32_e64 v243, v243 clamp
    v_exp_f32_e64 v244, v244 clamp
    v_exp_f32_e64 v245, v245 clamp
    v_exp_f32_e64 v246, v246 clamp
    v_exp_f32_e64 v247, v247 clamp
    v_exp_f32_e64 v248, v248 clamp
    v_exp_f32_e64 v249, v249 clamp
    v_exp_f32_e64 v250, v250 clamp
    v_exp_f32_e64 v251, v251 clamp
    v_exp_f32_e64 v252, v252 clamp
    v_exp_f32_e64 v253, v253 clamp
    v_exp_f32_e64 v254, v254 clamp
    v_exp_f32_e64 v255, v255 clamp
    v_max_f32 v112, s63, v112
    v_max_f32 v113, s63, v113
    v_max_f32 v114, s63, v114
    v_max_f32 v115, s63, v115
    v_max_f32 v116, s63, v116
    v_max_f32 v117, s63, v117
    v_max_f32 v118, s63, v118
    v_max_f32 v119, s63, v119
    v_max_f32 v120, s63, v120
    v_max_f32 v121, s63, v121
    v_max_f32 v122, s63, v122
    v_max_f32 v123, s63, v123
    v_max_f32 v124, s63, v124
    v_max_f32 v125, s63, v125
    v_max_f32 v126, s63, v126
    v_max_f32 v127, s63, v127
    v_add_f32 v240, v240, v112
    v_add_f32 v241, v241, v113
    v_add_f32 v242, v242, v114
    v_add_f32 v243, v243, v115
    v_add_f32 v244, v244, v116
    v_add_f32 v245, v245, v117
    v_add_f32 v246, v246, v118
    v_add_f32 v247, v247, v119
    v_add_f32 v248, v248, v120
    v_add_f32 v249, v249, v121
    v_add_f32 v250, v250, v122
    v_add_f32 v251, v251, v123
    v_add_f32 v252, v252, v124
    v_add_f32 v253, v253, v125
    v_add_f32 v254, v254, v126
    v_add_f32 v255, v255, v127
    v_cvt_pk_bf16_f32 v176, v240, v241
    v_cvt_pk_bf16_f32 v177, v242, v243
    v_cvt_pk_bf16_f32 v178, v244, v245
    v_cvt_pk_bf16_f32 v179, v246, v247
    v_cvt_pk_bf16_f32 v180, v248, v249
    v_cvt_pk_bf16_f32 v181, v250, v251
    v_cvt_pk_bf16_f32 v182, v252, v253
    v_cvt_pk_bf16_f32 v183, v254, v255
    v_cvt_pk_bf16_f32 v192, v144, v145
    v_cvt_pk_bf16_f32 v193, v146, v147
    v_cvt_pk_bf16_f32 v194, v148, v149
    v_cvt_pk_bf16_f32 v195, v150, v151
    v_cvt_pk_bf16_f32 v196, v152, v153
    v_cvt_pk_bf16_f32 v197, v154, v155
    v_cvt_pk_bf16_f32 v198, v156, v157
    v_cvt_pk_bf16_f32 v199, v158, v159
    v_cvt_pk_bf16_f32 v200, v160, v161
    v_cvt_pk_bf16_f32 v201, v162, v163
    v_cvt_pk_bf16_f32 v202, v164, v165
    v_cvt_pk_bf16_f32 v203, v166, v167
    v_cvt_pk_bf16_f32 v204, v168, v169
    v_cvt_pk_bf16_f32 v205, v170, v171
    v_cvt_pk_bf16_f32 v206, v172, v173
    v_cvt_pk_bf16_f32 v207, v174, v175
    v_mfma_f32_16x16x32_bf16 v[216:219], v[176:179], v[192:195], 0
    v_mfma_f32_16x16x32_bf16 v[220:223], v[176:179], v[212:215], 0
    v_mfma_f32_16x16x32_bf16 v[216:219], v[180:183], v[196:199], v[216:219]
    v_mfma_f32_16x16x32_bf16 v[220:223], v[180:183], v[212:215], v[220:223]
    v_fma_f32 v240, v128, s64, v6
    v_fma_f32 v241, v129, s64, v6
    v_fma_f32 v242, v130, s64, v6
    s_barrier
    ds_read_b64_tr_b16 v[32:33], v21 offset:0
    v_fma_f32 v243, v131, s64, v6
    v_fma_f32 v244, v132, s64, v6
    v_fma_f32 v245, v133, s64, v6
    v_fma_f32 v246, v134, s64, v6
    v_fma_f32 v247, v135, s64, v6
    ds_read_b64_tr_b16 v[34:35], v21 offset:2048
    v_fma_f32 v248, v136, s64, v6
    v_fma_f32 v249, v137, s64, v6
    v_fma_f32 v250, v138, s64, v6
    v_fma_f32 v251, v139, s64, v6
    v_fma_f32 v252, v140, s64, v6
    ds_read_b64_tr_b16 v[36:37], v22 offset:0
    v_fma_f32 v253, v141, s64, v6
    v_fma_f32 v254, v142, s64, v6
    v_fma_f32 v255, v143, s64, v6
    v_exp_f32_e64 v240, v240 clamp
    v_exp_f32_e64 v241, v241 clamp
    v_exp_f32_e64 v242, v242 clamp
    ds_read_b64_tr_b16 v[38:39], v22 offset:2048
    v_exp_f32_e64 v243, v243 clamp
    v_exp_f32_e64 v244, v244 clamp
    v_exp_f32_e64 v245, v245 clamp
    v_exp_f32_e64 v246, v246 clamp
    v_exp_f32_e64 v247, v247 clamp
    ds_read_b64_tr_b16 v[40:41], v23 offset:0
    v_exp_f32_e64 v248, v248 clamp
    v_exp_f32_e64 v249, v249 clamp
    v_exp_f32_e64 v250, v250 clamp
    v_exp_f32_e64 v251, v251 clamp
    v_exp_f32_e64 v252, v252 clamp
    v_exp_f32_e64 v253, v253 clamp
    ds_read_b64_tr_b16 v[42:43], v23 offset:2048
    v_exp_f32_e64 v254, v254 clamp
    v_exp_f32_e64 v255, v255 clamp
    v_max_f32 v128, s63, v128
    v_max_f32 v129, s63, v129
    v_max_f32 v130, s63, v130
    ds_read_b64_tr_b16 v[44:45], v24 offset:0
    v_max_f32 v131, s63, v131
    v_max_f32 v132, s63, v132
    v_max_f32 v133, s63, v133
    v_max_f32 v134, s63, v134
    v_max_f32 v135, s63, v135
    v_max_f32 v136, s63, v136
    ds_read_b64_tr_b16 v[46:47], v24 offset:2048
    v_max_f32 v137, s63, v137
    v_max_f32 v138, s63, v138
    v_max_f32 v139, s63, v139
    v_max_f32 v140, s63, v140
    v_max_f32 v141, s63, v141
    ds_read_b64_tr_b16 v[48:49], v21 offset:16384
    v_max_f32 v142, s63, v142
    v_max_f32 v143, s63, v143
    v_add_f32 v240, v240, v128
    v_add_f32 v241, v241, v129
    v_add_f32 v242, v242, v130
    ds_read_b64_tr_b16 v[50:51], v21 offset:18432
    v_add_f32 v243, v243, v131
    v_add_f32 v244, v244, v132
    v_add_f32 v245, v245, v133
    v_add_f32 v246, v246, v134
    v_add_f32 v247, v247, v135
    v_add_f32 v248, v248, v136
    ds_read_b64_tr_b16 v[52:53], v22 offset:16384
    v_add_f32 v249, v249, v137
    v_add_f32 v250, v250, v138
    v_add_f32 v251, v251, v139
    v_add_f32 v252, v252, v140
    v_add_f32 v253, v253, v141
    ds_read_b64_tr_b16 v[54:55], v22 offset:18432
    v_add_f32 v254, v254, v142
    v_add_f32 v255, v255, v143
    v_cvt_pk_bf16_f32 v184, v240, v241
    v_cvt_pk_bf16_f32 v185, v242, v243
    v_cvt_pk_bf16_f32 v186, v244, v245
    v_cvt_pk_bf16_f32 v187, v246, v247
    ds_read_b64_tr_b16 v[56:57], v23 offset:16384
    v_cvt_pk_bf16_f32 v188, v248, v249
    v_cvt_pk_bf16_f32 v189, v250, v251
    v_cvt_pk_bf16_f32 v190, v252, v253
    v_cvt_pk_bf16_f32 v191, v254, v255
    v_mfma_f32_16x16x32_bf16 v[216:219], v[184:187], v[200:203], v[216:219]
    ds_read_b64_tr_b16 v[58:59], v23 offset:18432
    v_mfma_f32_16x16x32_bf16 v[220:223], v[184:187], v[212:215], v[220:223]
    v_mfma_f32_16x16x32_bf16 v[216:219], v[188:191], v[204:207], v[216:219]
    v_mfma_f32_16x16x32_bf16 v[220:223], v[188:191], v[212:215], v[220:223]
    s_nop 6
    v_cvt_pk_bf16_f32 v240, v216, v217
    v_cvt_pk_bf16_f32 v241, v218, v219
    v_cvt_pk_bf16_f32 v242, v220, v221
    ds_read_b64_tr_b16 v[60:61], v24 offset:16384
    v_cvt_pk_bf16_f32 v243, v222, v223
    v_add_u32 v244, v240, v241
    buffer_store_dwordx2 v[240:241], v3, s[24:27], s87 offen sc1
    s_nop 0
    v_add_u32_dpp v244, v244, v244 row_ror:8 row_mask:0xf bank_mask:0xf
    s_nop 1
    v_add_u32_dpp v244, v244, v244 row_ror:4 row_mask:0xf bank_mask:0xf
    ds_read_b64_tr_b16 v[62:63], v24 offset:18432
    s_nop 0
    v_add_u32_dpp v244, v244, v244 row_ror:2 row_mask:0xf bank_mask:0xf
    s_nop 1
    v_add_u32_dpp v244, v244, v244 row_ror:1 row_mask:0xf bank_mask:0xf
    v_add3_u32 v244, v244, v242, v243
    v_sub_u32 v244, s61, v244
    buffer_store_dwordx3 v[242:244], v5, s[24:27], s88 offen sc1
    s_and_b32 s87, s87, 0xffffe000
    s_waitcnt lgkmcnt(0)
    s_barrier
    ds_read_b64_tr_b16 v[64:65], v21 offset:32768
    ds_read_b64_tr_b16 v[66:67], v21 offset:34816
    ds_read_b64_tr_b16 v[68:69], v22 offset:32768
    ds_read_b64_tr_b16 v[70:71], v22 offset:34816
    ds_read_b64_tr_b16 v[72:73], v23 offset:32768
    ds_read_b64_tr_b16 v[74:75], v23 offset:34816
    s_add_u32 s89, s87, 4096
    ds_read_b64_tr_b16 v[76:77], v24 offset:32768
    ds_read_b64_tr_b16 v[78:79], v24 offset:34816
    ds_read_b64_tr_b16 v[80:81], v21 offset:49152
    ds_read_b64_tr_b16 v[82:83], v21 offset:51200
    ds_read_b64_tr_b16 v[84:85], v22 offset:49152
    s_and_b32 s88, s88, 0xfffffc00
    ds_read_b64_tr_b16 v[86:87], v22 offset:51200
    ds_read_b64_tr_b16 v[88:89], v23 offset:49152
    ds_read_b64_tr_b16 v[90:91], v23 offset:51200
    ds_read_b64_tr_b16 v[92:93], v24 offset:49152
    ds_read_b64_tr_b16 v[94:95], v24 offset:51200
    s_lshl_b32 s90, s61, 6
    s_waitcnt lgkmcnt(0)
    s_barrier
    v_add_u32 v21, 0x10000, v21
    v_add_u32 v22, 0x10000, v22
    v_add_u32 v23, 0x10000, v23
    v_add_u32 v24, 0x10000, v24
    ds_read_b64_tr_b16 v[96:97], v21 offset:0
    ds_read_b64_tr_b16 v[98:99], v21 offset:2048
    ds_read_b64_tr_b16 v[100:101], v22 offset:0
    ds_read_b64_tr_b16 v[102:103], v22 offset:2048
    ds_read_b64_tr_b16 v[104:105], v23 offset:0
    ds_read_b64_tr_b16 v[106:107], v23 offset:2048
    ds_read_b64_tr_b16 v[108:109], v24 offset:0
    ds_read_b64_tr_b16 v[110:111], v24 offset:2048
    s_waitcnt lgkmcnt(0)
    s_barrier
    s_setprio 0
    buffer_load_dwordx3 v[228:230], v12, s[24:27], s88 offen sc1
    buffer_load_dwordx4 v[176:179], v2, s[24:27], s87 offen offset:0 sc1
    buffer_load_dwordx4 v[180:183], v2, s[24:27], s87 offen offset:1024 sc1
    buffer_load_dwordx4 v[184:187], v2, s[24:27], s87 offen offset:2048 sc1
    buffer_load_dwordx4 v[188:191], v2, s[24:27], s87 offen offset:3072 sc1
    buffer_load_dwordx4 v[192:195], v2, s[24:27], s89 offen offset:0 sc1
    buffer_load_dwordx4 v[196:199], v2, s[24:27], s89 offen offset:1024 sc1
    buffer_load_dwordx4 v[200:203], v2, s[24:27], s89 offen offset:2048 sc1
    buffer_load_dwordx4 v[204:207], v2, s[24:27], s89 offen offset:3072 sc1
L_kvc:
    s_nop 1
    s_waitcnt vmcnt(8)
    v_and_b32 v243, 0xffff0000, v229
    v_lshlrev_b32 v242, 16, v229
    v_and_b32 v241, 0xffff0000, v228
    v_lshlrev_b32 v240, 16, v228
    v_add3_u32 v244, v228, v229, v230
    s_nop 0
    v_add_f32_dpp v240, v240, v240 row_ror:8 row_mask:0xf bank_mask:0xf
    v_add_f32_dpp v241, v241, v241 row_ror:8 row_mask:0xf bank_mask:0xf
    v_add_f32_dpp v242, v242, v242 row_ror:8 row_mask:0xf bank_mask:0xf
    v_add_f32_dpp v243, v243, v243 row_ror:8 row_mask:0xf bank_mask:0xf
    v_add_f32_dpp v240, v240, v240 row_ror:4 row_mask:0xf bank_mask:0xf
    v_add_f32_dpp v241, v241, v241 row_ror:4 row_mask:0xf bank_mask:0xf
    v_add_f32_dpp v242, v242, v242 row_ror:4 row_mask:0xf bank_mask:0xf
    v_add_f32_dpp v243, v243, v243 row_ror:4 row_mask:0xf bank_mask:0xf
    v_add_f32_dpp v240, v240, v240 row_ror:2 row_mask:0xf bank_mask:0xf
    v_add_f32_dpp v241, v241, v241 row_ror:2 row_mask:0xf bank_mask:0xf
    v_add_f32_dpp v242, v242, v242 row_ror:2 row_mask:0xf bank_mask:0xf
    v_add_f32_dpp v243, v243, v243 row_ror:2 row_mask:0xf bank_mask:0xf
    v_add_f32_dpp v240, v240, v240 row_ror:1 row_mask:0xf bank_mask:0xf
    v_add_f32_dpp v241, v241, v241 row_ror:1 row_mask:0xf bank_mask:0xf
    v_add_f32_dpp v242, v242, v242 row_ror:1 row_mask:0xf bank_mask:0xf
    v_add_f32_dpp v243, v243, v243 row_ror:1 row_mask:0xf bank_mask:0xf
    v_cvt_pk_bf16_f32 v240, v240, v241
    v_cvt_pk_bf16_f32 v241, v242, v243
    ds_write_b64 v9, v[240:241] offset:47104
    s_waitcnt vmcnt(7)
    v_mfma_f32_16x16x32_bf16 v[248:251], v[224:227], v[176:179], 0
    v_add3_u32 v244, v244, v176, v177
    v_add_u32 v245, v178, v179
    s_waitcnt vmcnt(6)
    v_mfma_f32_16x16x32_bf16 v[248:251], v[224:227], v[180:183], v[248:251]
    v_add3_u32 v244, v244, v180, v181
    v_add3_u32 v245, v245, v182, v183
    s_waitcnt vmcnt(5)
    v_mfma_f32_16x16x32_bf16 v[248:251], v[224:227], v[184:187], v[248:251]
    v_add3_u32 v244, v244, v184, v185
    v_add3_u32 v245, v245, v186, v187
    s_waitcnt vmcnt(4)
    v_mfma_f32_16x16x32_bf16 v[248:251], v[224:227], v[188:191], v[248:251]
    v_add3_u32 v244, v244, v188, v189
    v_add3_u32 v245, v245, v190, v191
    s_waitcnt vmcnt(3)
    v_mfma_f32_16x16x32_bf16 v[248:251], v[224:227], v[192:195], v[248:251]
    v_add3_u32 v244, v244, v192, v193
    v_add3_u32 v245, v245, v194, v195
    s_waitcnt vmcnt(2)
    v_mfma_f32_16x16x32_bf16 v[248:251], v[224:227], v[196:199], v[248:251]
    v_add3_u32 v244, v244, v196, v197
    v_add3_u32 v245, v245, v198, v199
    s_waitcnt vmcnt(1)
    v_mfma_f32_16x16x32_bf16 v[248:251], v[224:227], v[200:203], v[248:251]
    v_add3_u32 v244, v244, v200, v201
    v_add3_u32 v245, v245, v202, v203
    s_waitcnt vmcnt(0)
    v_mfma_f32_16x16x32_bf16 v[248:251], v[224:227], v[204:207], v[248:251]
    v_add3_u32 v244, v244, v204, v205
    v_add3_u32 v245, v245, v206, v207
    v_add_u32 v244, v244, v245
    s_nop 1
    v_add_u32_dpp v244, v244, v244 row_ror:8 row_mask:0xf bank_mask:0xf
    s_nop 1
    v_add_u32_dpp v244, v244, v244 row_ror:4 row_mask:0xf bank_mask:0xf
    v_cvt_pk_bf16_f32 v248, v248, v249
    s_nop 0
    v_add_u32_dpp v244, v244, v244 row_ror:2 row_mask:0xf bank_mask:0xf
    v_cvt_pk_bf16_f32 v249, v250, v251
    s_nop 0
    v_add_u32_dpp v244, v244, v244 row_ror:1 row_mask:0xf bank_mask:0xf
    v_mov_b32 v245, v244
    ds_write_b64 v8, v[248:249] offset:45056
    s_nop 0
    v_permlane16_swap_b32 v244, v245
    v_add_u32 v244, v244, v245
    v_mov_b32 v245, v244
    s_nop 1
    v_permlane32_swap_b32 v244, v245
    v_add_u32 v244, v244, v245
    v_cmp_ne_u32 vcc, s90, v244
    s_cbranch_vccnz L_kvs
L_kvd:
    s_waitcnt lgkmcnt(0)
    s_barrier
    buffer_load_dwordx4 v[112:115], v25, s[24:27], s72 offen sc1
    buffer_load_dwordx4 v[116:119], v26, s[24:27], s72 offen sc1
    buffer_load_dword v160, v27, s[24:27], s72 offen sc1
    buffer_load_dwordx4 v[120:123], v25, s[24:27], s73 offen sc1
    buffer_load_dwordx4 v[124:127], v26, s[24:27], s73 offen sc1
    buffer_load_dword v161, v27, s[24:27], s73 offen sc1
    buffer_load_dwordx4 v[128:131], v25, s[24:27], s74 offen sc1
    buffer_load_dwordx4 v[132:135], v26, s[24:27], s74 offen sc1
    buffer_load_dword v162, v27, s[24:27], s74 offen sc1
    s_branch L_P2_0
L_G0B:
    s_and_b32 s68, s49, 1
    s_lshl_b32 s68, s68, 6
    s_mul_i32 s66, s51, 384
    s_add_u32 s66, s66, s68
    v_lshrrev_b32 v245, 4, v1
    v_lshlrev_b32 v245, 3, v245
    s_mov_b32 s18, 2752
    s_mov_b32 s19, 0x20000
    s_waitcnt lgkmcnt(0)
    buffer_load_dwordx2 v[208:209], v245, s[16:19], s66 offen offset:0
    buffer_load_dwordx2 v[212:213], v245, s[16:19], s66 offen offset:32
    buffer_load_dwordx2 v[216:217], v245, s[16:19], s66 offen offset:128
    buffer_load_dwordx2 v[220:221], v245, s[16:19], s66 offen offset:160
    s_mov_b32 s18, 2752
    s_mov_b32 s19, 0x20000
    s_mov_b32 s34, 1409024
    s_mov_b32 s35, 0x20000
    s_mov_b32 s38, 524288
    s_mov_b32 s39, 0x20000
    s_mov_b32 s46, 1024
    s_mov_b32 s47, 0x20000
    s_mov_b32 s42, 2097152
    s_mov_b32 s43, 0x20000
    s_and_b32 s66, s2, 7
    s_bfe_u32 s58, s2, 0x30004
    s_xor_b32 s67, s58, s52
    s_and_b32 s67, s67, 1
    s_lshr_b32 s68, s2, 7
    s_lshl1_add_u32 s67, s68, s67
    s_lshl2_add_u32 s57, s66, s67
    s_lshr_b32 s67, s58, 1
    s_lshl1_add_u32 s67, s68, s67
    s_and_b32 s67, s67, 3
    s_lshr_b32 s69, s49, 1
    s_lshl1_add_u32 s67, s67, s69
    s_lshl_b32 s83, s67, 12
    s_cmp_eq_u32 s67, 7
    s_cselect_b32 s67, 0, s67
    s_mul_i32 s72, s67, 12288
    v_and_b32 v242, 6, v240
    v_xor_b32 v242, v242, v241
    v_lshlrev_b32 v242, 4, v242
    v_lshl_add_u32 v13, v240, 10, v242
    s_lshl_b32 s66, s58, 7
    s_and_b32 s68, s49, 1
    s_lshl_b32 s68, s68, 15
    s_add_u32 s68, s68, s66
    v_add_u32 v13, s68, v13
    v_add_u32 v14, 0x2000, v13
    v_and_b32 v242, 15, v1
    v_lshrrev_b32 v243, 4, v1
    v_lshlrev_b32 v245, 3, v243
    s_and_b32 s68, s49, 2
    s_lshl_b32 s68, s68, 5
    s_add_u32 s66, s66, s68
    v_add_u32 v28, s66, v245
    v_bfe_u32 v244, v1, 1, 1
    v_and_b32 v245, 3, v240
    v_lshl_add_u32 v244, v245, 1, v244
    v_lshlrev_b32 v244, 4, v244
    v_and_b32 v245, 1, v1
    v_lshl_add_u32 v244, v245, 3, v244
    v_lshrrev_b32 v245, 2, v1
    v_lshl_add_u32 v245, v245, 7, v244
    v_add_u32 v245, s55, v245
    v_xor_b32 v21, s68, v245
    v_xor_b32 v22, 32, v21
    v_xor_b32 v23, 64, v21
    v_xor_b32 v24, 0x60, v21
    s_lshl1_add_u32 s70, s57, 0
    s_mul_i32 s66, s70, 122880
    s_and_b32 s67, s49, 1
    s_lshl_b32 s68, s67, 11
    s_add_u32 s66, s66, s68
    s_lshl_b32 s68, s67, 10
    v_xor_b32 v25, s68, v2
    v_xor_b32 v26, 0x400, v25
    v_add_u32 v25, s66, v25
    v_add_u32 v26, s66, v26
    s_lshr_b32 s66, s70, 3
    s_mul_i32 s66, s66, 122880
    s_and_b32 s70, s70, 7
    s_lshl1_add_u32 s70, s70, s67
    s_lshl_b32 s70, s70, 8
    s_add_u32 s66, s66, s70
    s_add_u32 s66, s66, 7864320
    v_lshl_add_u32 v27, v1, 2, s66
    s_mov_b32 s60, 0x4000
    s_cmp_lt_u32 s49, 3
    s_cselect_b32 s91, s55, 15360
    s_cselect_b32 s92, 1024, 0
    s_mov_b32 s3, 0
    s_add_u32 s73, s72, 24576
    s_sub_u32 s66, s73, 86016
    s_cselect_b32 s73, s73, s66
    s_add_u32 s74, s73, 24576
    s_sub_u32 s66, s74, 86016
    s_cselect_b32 s74, s74, s66
    s_add_u32 s75, s74, 24576
    s_sub_u32 s66, s75, 86016
    s_cselect_b32 s75, s75, s66
    s_add_u32 s76, s75, 24576
    s_sub_u32 s66, s76, 86016
    s_cselect_b32 s76, s76, s66
    s_add_u32 s77, s76, 24576
    s_sub_u32 s66, s77, 86016
    s_cselect_b32 s77, s77, s66
    s_add_u32 s78, s77, 24576
    s_sub_u32 s66, s78, 86016
    s_cselect_b32 s78, s78, s66
    s_add_u32 s79, s78, 24576
    s_sub_u32 s66, s79, 86016
    s_cselect_b32 s79, s79, s66
    s_add_u32 s80, s79, 24576
    s_sub_u32 s66, s80, 86016
    s_cselect_b32 s80, s80, s66
    s_add_u32 s81, s80, 24576
    s_sub_u32 s66, s81, 86016
    s_cselect_b32 s81, s81, s66
    s_add_u32 s82, s81, 24576
    s_sub_u32 s66, s82, 86016
    s_cselect_b32 s82, s82, s66
    s_add_u32 s84, s83, 8192
    s_and_b32 s84, s84, 0x7fff
    s_add_u32 s85, s84, 8192
    s_and_b32 s85, s85, 0x7fff
    s_add_u32 s86, s85, 8192
    s_and_b32 s86, s86, 0x7fff
    s_lshl_b32 s69, s69, 12
    s_add_u32 s75, s75, s69
    s_add_u32 s76, s76, 4096
    s_add_u32 s77, s77, 4096
    s_add_u32 s78, s78, 4096
    s_add_u32 s79, s79, 8192
    s_add_u32 s80, s80, 8192
    s_add_u32 s81, s81, 8192
    s_add_u32 s82, s82, 8192
    s_add_u32 s83, s83, 90112
    s_add_u32 s84, s84, 90112
    s_add_u32 s85, s85, 90112
    s_add_u32 s86, s86, 90112
    s_cmp_ge_u32 s49, 2
    s_cselect_b32 s82, 86016, s82
    s_cmp_eq_u32 s49, 3
    s_cselect_b32 s82, 0x7f200000, s82
    s_and_b32 s68, s49, 1
    s_lshl_b32 s68, s68, 6
    s_mul_i32 s66, s51, 12288
    s_and_b32 s67, s49, 2
    s_lshl2_add_u32 s67, s50, s67
    s_lshr_b32 s70, s67, 3
    s_sub_u32 s70, s67, s70
    s_mul_i32 s70, s70, 122880
    s_and_b32 s69, s67, 7
    s_lshl_b32 s69, s69, 9
    s_add_u32 s69, s69, 7864320
    s_sub_u32 s69, s69, s70
    s_mul_i32 s70, s68, 28
    s_sub_u32 s69, s69, s70
    v_lshl_add_u32 v12, v1, 2, s69
    v_subrev_u32 v5, 122368, v12
    s_mul_i32 s67, s67, 122880
    s_add_u32 s67, s67, s66
    s_mul_i32 s69, s68, 32
    s_add_u32 s87, s67, s69
    s_add_u32 s88, s87, 122880
    s_add_u32 s89, s87, 4096
    s_add_u32 s90, s88, 4096
    s_cmp_eq_u32 s59, 1
    s_cselect_b32 s89, 0x7f000000, s89
    s_cselect_b32 s90, 0x7f000000, s90
    s_and_b32 s67, s49, 2
    s_lshl_b32 s67, s67, 12
    v_lshrrev_b32 v245, 1, v242
    v_xor_b32 v245, v245, v243
    v_lshlrev_b32 v245, 4, v245
    v_lshl_add_u32 v245, v242, 7, v245
    v_add_u32 v15, s67, v245
    v_xor_b32 v16, 64, v15
    v_bfe_u32 v245, v1, 2, 2
    v_lshl_add_u32 v245, v243, 3, v245
    v_lshl_add_u32 v245, v245, 7, v244
    v_xor_b32 v17, s68, v245
    v_xor_b32 v18, 32, v17
    s_lshr_b32 s69, s2, 3
    s_mul_i32 s66, s2, 5504
    s_lshl_b32 s68, s2, 11
    s_cmp_eq_u32 s49, 1
    s_cselect_b32 s66, s66, 0x7f000000
    s_cmp_eq_u32 s49, 2
    s_cselect_b32 s68, s68, 0x7f000000
    s_movk_i32 s71, 15
    s_mov_b32 s66, 0x7f000000
    s_mov_b32 s68, 0x7f000000
    s_movk_i32 s67, 7
    s_mul_i32 s70, s69, 44032
    s_add_u32 s70, s70, 384
    s_cmp_eq_u32 s49, 0
    s_cselect_b32 s66, s70, s66
    s_cselect_b32 s67, 10, s67
    s_lshl_b32 s70, s69, 14
    s_add_u32 s70, s70, 384
    s_cmp_eq_u32 s49, 3
    s_cselect_b32 s68, s70, s68
    s_cselect_b32 s67, 10, s67
    s_cselect_b32 s71, 15, s71
    v_min_u32 v246, 42, v1
    v_and_b32 v247, s71, v1
    v_lshlrev_b32 v246, s67, v246
    v_lshlrev_b32 v247, s67, v247
    s_mov_b32 s64, 0xbdd2d3e8
    s_mov_b32 s65, 0xbdd2d3e8
    s_mov_b32 s63, 0x358637bd
    v_mov_b32 v6, 0xc0135761
    v_mov_b32 v7, 0xc0135761
    s_waitcnt vmcnt(3)
    v_and_b32 v211, 0xffff0000, v209
    v_lshlrev_b32 v210, 16, v209
    v_and_b32 v209, 0xffff0000, v208
    v_lshlrev_b32 v208, 16, v208
    s_waitcnt vmcnt(2)
    v_and_b32 v215, 0xffff0000, v213
    v_lshlrev_b32 v214, 16, v213
    v_and_b32 v213, 0xffff0000, v212
    v_lshlrev_b32 v212, 16, v212
    s_waitcnt vmcnt(1)
    v_and_b32 v219, 0xffff0000, v217
    v_lshlrev_b32 v218, 16, v217
    v_and_b32 v217, 0xffff0000, v216
    v_lshlrev_b32 v216, 16, v216
    s_waitcnt vmcnt(0)
    v_and_b32 v223, 0xffff0000, v221
    v_lshlrev_b32 v222, 16, v221
    v_and_b32 v221, 0xffff0000, v220
    v_lshlrev_b32 v220, 16, v220
    s_setprio 1
    s_barrier
    ds_read_b64_tr_b16 v[48:49], v17 offset:16384
    ds_read_b64_tr_b16 v[50:51], v17 offset:16896
    ds_read_b128 v[32:35], v15 offset:0
    ds_read_b128 v[36:39], v15 offset:2048
    ds_read_b64_tr_b16 v[52:53], v18 offset:16384
    ds_read_b64_tr_b16 v[54:55], v18 offset:16896
    ds_read_b128 v[40:43], v15 offset:4096
    ds_read_b128 v[44:47], v15 offset:6144
    ds_read_b64_tr_b16 v[56:57], v17 offset:24576
    ds_read_b64_tr_b16 v[58:59], v17 offset:25088
    ds_read_b64_tr_b16 v[60:61], v18 offset:24576
    ds_read_b64_tr_b16 v[62:63], v18 offset:25088
    s_waitcnt lgkmcnt(4)
    v_mfma_f32_16x16x32_bf16 v[160:163], v[48:51], v[32:35], v[208:211]
    ds_read_b64_tr_b16 v[80:81], v17 offset:20480
    v_mfma_f32_16x16x32_bf16 v[168:171], v[48:51], v[36:39], v[208:211]
    ds_read_b64_tr_b16 v[82:83], v17 offset:20992
    v_mfma_f32_16x16x32_bf16 v[164:167], v[52:55], v[32:35], v[212:215]
    ds_read_b128 v[64:67], v16 offset:0
    v_mfma_f32_16x16x32_bf16 v[172:175], v[52:55], v[36:39], v[212:215]
    ds_read_b128 v[68:71], v16 offset:2048
    v_mfma_f32_16x16x32_bf16 v[112:115], v[48:51], v[40:43], v[208:211]
    ds_read_b64_tr_b16 v[84:85], v18 offset:20480
    v_mfma_f32_16x16x32_bf16 v[120:123], v[48:51], v[44:47], v[208:211]
    ds_read_b64_tr_b16 v[86:87], v18 offset:20992
    v_mfma_f32_16x16x32_bf16 v[116:119], v[52:55], v[40:43], v[212:215]
    ds_read_b128 v[72:75], v16 offset:4096
    v_mfma_f32_16x16x32_bf16 v[124:127], v[52:55], v[44:47], v[212:215]
    ds_read_b128 v[76:79], v16 offset:6144
    s_waitcnt lgkmcnt(8)
    v_mfma_f32_16x16x32_bf16 v[128:131], v[56:59], v[32:35], v[216:219]
    ds_read_b64_tr_b16 v[88:89], v17 offset:28672
    v_mfma_f32_16x16x32_bf16 v[136:139], v[56:59], v[36:39], v[216:219]
    ds_read_b64_tr_b16 v[90:91], v17 offset:29184
    v_mfma_f32_16x16x32_bf16 v[144:147], v[56:59], v[40:43], v[216:219]
    ds_read_b64_tr_b16 v[92:93], v18 offset:28672
    v_mfma_f32_16x16x32_bf16 v[152:155], v[56:59], v[44:47], v[216:219]
    ds_read_b64_tr_b16 v[94:95], v18 offset:29184
    v_mfma_f32_16x16x32_bf16 v[132:135], v[60:63], v[32:35], v[220:223]
    v_mfma_f32_16x16x32_bf16 v[140:143], v[60:63], v[36:39], v[220:223]
    v_mfma_f32_16x16x32_bf16 v[148:151], v[60:63], v[40:43], v[220:223]
    v_mfma_f32_16x16x32_bf16 v[156:159], v[60:63], v[44:47], v[220:223]
    s_barrier
    s_waitcnt lgkmcnt(4)
    v_mfma_f32_16x16x32_bf16 v[160:163], v[80:83], v[64:67], v[160:163]
    ds_read_b64_tr_b16 v[48:49], v17 offset:49152
    v_mfma_f32_16x16x32_bf16 v[168:171], v[80:83], v[68:71], v[168:171]
    ds_read_b64_tr_b16 v[50:51], v17 offset:49664
    v_mfma_f32_16x16x32_bf16 v[164:167], v[84:87], v[64:67], v[164:167]
    ds_read_b128 v[32:35], v15 offset:32768
    v_mfma_f32_16x16x32_bf16 v[172:175], v[84:87], v[68:71], v[172:175]
    ds_read_b128 v[36:39], v15 offset:34816
    v_mfma_f32_16x16x32_bf16 v[112:115], v[80:83], v[72:75], v[112:115]
    ds_read_b64_tr_b16 v[52:53], v18 offset:49152
    v_mfma_f32_16x16x32_bf16 v[120:123], v[80:83], v[76:79], v[120:123]
    ds_read_b64_tr_b16 v[54:55], v18 offset:49664
    v_mfma_f32_16x16x32_bf16 v[116:119], v[84:87], v[72:75], v[116:119]
    ds_read_b128 v[40:43], v15 offset:36864
    v_mfma_f32_16x16x32_bf16 v[124:127], v[84:87], v[76:79], v[124:127]
    ds_read_b128 v[44:47], v15 offset:38912
    s_waitcnt lgkmcnt(8)
    v_mfma_f32_16x16x32_bf16 v[128:131], v[88:91], v[64:67], v[128:131]
    ds_read_b64_tr_b16 v[56:57], v17 offset:57344
    v_mfma_f32_16x16x32_bf16 v[136:139], v[88:91], v[68:71], v[136:139]
    ds_read_b64_tr_b16 v[58:59], v17 offset:57856
    v_mfma_f32_16x16x32_bf16 v[144:147], v[88:91], v[72:75], v[144:147]
    ds_read_b64_tr_b16 v[60:61], v18 offset:57344
    v_mfma_f32_16x16x32_bf16 v[152:155], v[88:91], v[76:79], v[152:155]
    ds_read_b64_tr_b16 v[62:63], v18 offset:57856
    v_mfma_f32_16x16x32_bf16 v[132:135], v[92:95], v[64:67], v[132:135]
    v_mfma_f32_16x16x32_bf16 v[140:143], v[92:95], v[68:71], v[140:143]
    v_mfma_f32_16x16x32_bf16 v[148:151], v[92:95], v[72:75], v[148:151]
    v_mfma_f32_16x16x32_bf16 v[156:159], v[92:95], v[76:79], v[156:159]
    s_waitcnt lgkmcnt(4)
    v_mfma_f32_16x16x32_bf16 v[160:163], v[48:51], v[32:35], v[160:163]
    ds_read_b64_tr_b16 v[80:81], v17 offset:53248
    v_mfma_f32_16x16x32_bf16 v[168:171], v[48:51], v[36:39], v[168:171]
    ds_read_b64_tr_b16 v[82:83], v17 offset:53760
    v_mfma_f32_16x16x32_bf16 v[164:167], v[52:55], v[32:35], v[164:167]
    ds_read_b128 v[64:67], v16 offset:32768
    v_mfma_f32_16x16x32_bf16 v[172:175], v[52:55], v[36:39], v[172:175]
    ds_read_b128 v[68:71], v16 offset:34816
    v_mfma_f32_16x16x32_bf16 v[112:115], v[48:51], v[40:43], v[112:115]
    ds_read_b64_tr_b16 v[84:85], v18 offset:53248
    v_mfma_f32_16x16x32_bf16 v[120:123], v[48:51], v[44:47], v[120:123]
    ds_read_b64_tr_b16 v[86:87], v18 offset:53760
    v_mfma_f32_16x16x32_bf16 v[116:119], v[52:55], v[40:43], v[116:119]
    ds_read_b128 v[72:75], v16 offset:36864
    v_mfma_f32_16x16x32_bf16 v[124:127], v[52:55], v[44:47], v[124:127]
    ds_read_b128 v[76:79], v16 offset:38912
    s_waitcnt lgkmcnt(8)
    v_mfma_f32_16x16x32_bf16 v[128:131], v[56:59], v[32:35], v[128:131]
    ds_read_b64_tr_b16 v[88:89], v17 offset:61440
    v_mfma_f32_16x16x32_bf16 v[136:139], v[56:59], v[36:39], v[136:139]
    ds_read_b64_tr_b16 v[90:91], v17 offset:61952
    v_mfma_f32_16x16x32_bf16 v[144:147], v[56:59], v[40:43], v[144:147]
    ds_read_b64_tr_b16 v[92:93], v18 offset:61440
    v_mfma_f32_16x16x32_bf16 v[152:155], v[56:59], v[44:47], v[152:155]
    ds_read_b64_tr_b16 v[94:95], v18 offset:61952
    v_mfma_f32_16x16x32_bf16 v[132:135], v[60:63], v[32:35], v[132:135]
    v_mfma_f32_16x16x32_bf16 v[140:143], v[60:63], v[36:39], v[140:143]
    v_mfma_f32_16x16x32_bf16 v[148:151], v[60:63], v[40:43], v[148:151]
    v_mfma_f32_16x16x32_bf16 v[156:159], v[60:63], v[44:47], v[156:159]
    s_barrier
    s_waitcnt lgkmcnt(4)
    v_mfma_f32_16x16x32_bf16 v[160:163], v[80:83], v[64:67], v[160:163]
    v_add_u32 v17, 0x10000, v17
    v_add_u32 v18, 0x10000, v18
    v_mfma_f32_16x16x32_bf16 v[168:171], v[80:83], v[68:71], v[168:171]
    v_add_u32 v15, 0x10000, v15
    v_mfma_f32_16x16x32_bf16 v[164:167], v[84:87], v[64:67], v[164:167]
    v_add_u32 v16, 0x10000, v16
    v_mfma_f32_16x16x32_bf16 v[172:175], v[84:87], v[68:71], v[172:175]
    ds_read_b64_tr_b16 v[48:49], v17 offset:16384
    ds_read_b64_tr_b16 v[50:51], v17 offset:16896
    v_mfma_f32_16x16x32_bf16 v[112:115], v[80:83], v[72:75], v[112:115]
    ds_read_b128 v[32:35], v15 offset:0
    v_mfma_f32_16x16x32_bf16 v[120:123], v[80:83], v[76:79], v[120:123]
    ds_read_b128 v[36:39], v15 offset:2048
    v_mfma_f32_16x16x32_bf16 v[116:119], v[84:87], v[72:75], v[116:119]
    ds_read_b64_tr_b16 v[52:53], v18 offset:16384
    ds_read_b64_tr_b16 v[54:55], v18 offset:16896
    v_mfma_f32_16x16x32_bf16 v[124:127], v[84:87], v[76:79], v[124:127]
    ds_read_b128 v[40:43], v15 offset:4096
    s_waitcnt lgkmcnt(7)
    v_mfma_f32_16x16x32_bf16 v[128:131], v[88:91], v[64:67], v[128:131]
    ds_read_b128 v[44:47], v15 offset:6144
    v_mfma_f32_16x16x32_bf16 v[136:139], v[88:91], v[68:71], v[136:139]
    ds_read_b64_tr_b16 v[56:57], v17 offset:24576
    ds_read_b64_tr_b16 v[58:59], v17 offset:25088
    v_mfma_f32_16x16x32_bf16 v[144:147], v[88:91], v[72:75], v[144:147]
    ds_read_b64_tr_b16 v[60:61], v18 offset:24576
    v_mfma_f32_16x16x32_bf16 v[152:155], v[88:91], v[76:79], v[152:155]
    ds_read_b64_tr_b16 v[62:63], v18 offset:25088
    v_mfma_f32_16x16x32_bf16 v[132:135], v[92:95], v[64:67], v[132:135]
    v_mfma_f32_16x16x32_bf16 v[140:143], v[92:95], v[68:71], v[140:143]
    v_mfma_f32_16x16x32_bf16 v[148:151], v[92:95], v[72:75], v[148:151]
    v_mfma_f32_16x16x32_bf16 v[156:159], v[92:95], v[76:79], v[156:159]
    s_waitcnt lgkmcnt(4)
    v_mfma_f32_16x16x32_bf16 v[160:163], v[48:51], v[32:35], v[160:163]
    ds_read_b64_tr_b16 v[80:81], v17 offset:20480
    ds_read_b64_tr_b16 v[82:83], v17 offset:20992
    v_mfma_f32_16x16x32_bf16 v[168:171], v[48:51], v[36:39], v[168:171]
    ds_read_b128 v[64:67], v16 offset:0
    v_mfma_f32_16x16x32_bf16 v[164:167], v[52:55], v[32:35], v[164:167]
    ds_read_b128 v[68:71], v16 offset:2048
    v_mfma_f32_16x16x32_bf16 v[172:175], v[52:55], v[36:39], v[172:175]
    ds_read_b64_tr_b16 v[84:85], v18 offset:20480
    v_mfma_f32_16x16x32_bf16 v[112:115], v[48:51], v[40:43], v[112:115]
    ds_read_b64_tr_b16 v[86:87], v18 offset:20992
    v_mfma_f32_16x16x32_bf16 v[120:123], v[48:51], v[44:47], v[120:123]
    ds_read_b128 v[72:75], v16 offset:4096
    v_mfma_f32_16x16x32_bf16 v[116:119], v[52:55], v[40:43], v[116:119]
    ds_read_b128 v[76:79], v16 offset:6144
    ds_read_b64_tr_b16 v[88:89], v17 offset:28672
    v_mfma_f32_16x16x32_bf16 v[124:127], v[52:55], v[44:47], v[124:127]
    ds_read_b64_tr_b16 v[90:91], v17 offset:29184
    s_waitcnt lgkmcnt(10)
    v_mfma_f32_16x16x32_bf16 v[128:131], v[56:59], v[32:35], v[128:131]
    ds_read_b64_tr_b16 v[92:93], v18 offset:28672
    v_mfma_f32_16x16x32_bf16 v[136:139], v[56:59], v[36:39], v[136:139]
    ds_read_b64_tr_b16 v[94:95], v18 offset:29184
    v_mfma_f32_16x16x32_bf16 v[144:147], v[56:59], v[40:43], v[144:147]
    buffer_load_dwordx2 v[30:31], v28, s[44:47], 0 offen offset:32
    v_mfma_f32_16x16x32_bf16 v[152:155], v[56:59], v[44:47], v[152:155]
    buffer_load_dwordx2 v[28:29], v28, s[44:47], 0 offen
    v_mfma_f32_16x16x32_bf16 v[132:135], v[60:63], v[32:35], v[132:135]
    v_mfma_f32_16x16x32_bf16 v[140:143], v[60:63], v[36:39], v[140:143]
    v_mfma_f32_16x16x32_bf16 v[148:151], v[60:63], v[40:43], v[148:151]
    v_mfma_f32_16x16x32_bf16 v[156:159], v[60:63], v[44:47], v[156:159]
    s_barrier
    s_waitcnt lgkmcnt(4)
    v_mfma_f32_16x16x32_bf16 v[160:163], v[80:83], v[64:67], v[160:163]
    ds_read_b64_tr_b16 v[48:49], v17 offset:49152
    v_mfma_f32_16x16x32_bf16 v[168:171], v[80:83], v[68:71], v[168:171]
    ds_read_b64_tr_b16 v[50:51], v17 offset:49664
    v_mfma_f32_16x16x32_bf16 v[164:167], v[84:87], v[64:67], v[164:167]
    ds_read_b128 v[32:35], v15 offset:32768
    v_mfma_f32_16x16x32_bf16 v[172:175], v[84:87], v[68:71], v[172:175]
    ds_read_b128 v[36:39], v15 offset:34816
    v_mfma_f32_16x16x32_bf16 v[112:115], v[80:83], v[72:75], v[112:115]
    ds_read_b64_tr_b16 v[52:53], v18 offset:49152
    v_mfma_f32_16x16x32_bf16 v[120:123], v[80:83], v[76:79], v[120:123]
    ds_read_b64_tr_b16 v[54:55], v18 offset:49664
    v_mfma_f32_16x16x32_bf16 v[116:119], v[84:87], v[72:75], v[116:119]
    ds_read_b128 v[40:43], v15 offset:36864
    v_mfma_f32_16x16x32_bf16 v[124:127], v[84:87], v[76:79], v[124:127]
    ds_read_b128 v[44:47], v15 offset:38912
    s_waitcnt lgkmcnt(8)
    v_mfma_f32_16x16x32_bf16 v[128:131], v[88:91], v[64:67], v[128:131]
    ds_read_b64_tr_b16 v[56:57], v17 offset:57344
    v_mfma_f32_16x16x32_bf16 v[136:139], v[88:91], v[68:71], v[136:139]
    ds_read_b64_tr_b16 v[58:59], v17 offset:57856
    v_mfma_f32_16x16x32_bf16 v[144:147], v[88:91], v[72:75], v[144:147]
    ds_read_b64_tr_b16 v[60:61], v18 offset:57344
    v_mfma_f32_16x16x32_bf16 v[152:155], v[88:91], v[76:79], v[152:155]
    ds_read_b64_tr_b16 v[62:63], v18 offset:57856
    v_mfma_f32_16x16x32_bf16 v[132:135], v[92:95], v[64:67], v[132:135]
    v_mfma_f32_16x16x32_bf16 v[140:143], v[92:95], v[68:71], v[140:143]
    v_mfma_f32_16x16x32_bf16 v[148:151], v[92:95], v[72:75], v[148:151]
    v_mfma_f32_16x16x32_bf16 v[156:159], v[92:95], v[76:79], v[156:159]
    s_waitcnt lgkmcnt(4)
    v_mfma_f32_16x16x32_bf16 v[160:163], v[48:51], v[32:35], v[160:163]
    ds_read_b64_tr_b16 v[80:81], v17 offset:53248
    v_mfma_f32_16x16x32_bf16 v[168:171], v[48:51], v[36:39], v[168:171]
    ds_read_b64_tr_b16 v[82:83], v17 offset:53760
    v_mfma_f32_16x16x32_bf16 v[164:167], v[52:55], v[32:35], v[164:167]
    ds_read_b128 v[64:67], v16 offset:32768
    v_mfma_f32_16x16x32_bf16 v[172:175], v[52:55], v[36:39], v[172:175]
    ds_read_b128 v[68:71], v16 offset:34816
    v_mfma_f32_16x16x32_bf16 v[112:115], v[48:51], v[40:43], v[112:115]
    ds_read_b64_tr_b16 v[84:85], v18 offset:53248
    v_mfma_f32_16x16x32_bf16 v[120:123], v[48:51], v[44:47], v[120:123]
    ds_read_b64_tr_b16 v[86:87], v18 offset:53760
    v_mfma_f32_16x16x32_bf16 v[116:119], v[52:55], v[40:43], v[116:119]
    ds_read_b128 v[72:75], v16 offset:36864
    v_mfma_f32_16x16x32_bf16 v[124:127], v[52:55], v[44:47], v[124:127]
    ds_read_b128 v[76:79], v16 offset:38912
    s_waitcnt lgkmcnt(8)
    v_mfma_f32_16x16x32_bf16 v[128:131], v[56:59], v[32:35], v[128:131]
    ds_read_b64_tr_b16 v[88:89], v17 offset:61440
    v_mfma_f32_16x16x32_bf16 v[136:139], v[56:59], v[36:39], v[136:139]
    ds_read_b64_tr_b16 v[90:91], v17 offset:61952
    v_mfma_f32_16x16x32_bf16 v[144:147], v[56:59], v[40:43], v[144:147]
    ds_read_b64_tr_b16 v[92:93], v18 offset:61440
    v_mfma_f32_16x16x32_bf16 v[152:155], v[56:59], v[44:47], v[152:155]
    ds_read_b64_tr_b16 v[94:95], v18 offset:61952
    v_mfma_f32_16x16x32_bf16 v[132:135], v[60:63], v[32:35], v[132:135]
    v_mfma_f32_16x16x32_bf16 v[140:143], v[60:63], v[36:39], v[140:143]
    v_mfma_f32_16x16x32_bf16 v[148:151], v[60:63], v[40:43], v[148:151]
    v_mfma_f32_16x16x32_bf16 v[156:159], v[60:63], v[44:47], v[156:159]
    s_barrier
    s_waitcnt lgkmcnt(4)
    v_mfma_f32_16x16x32_bf16 v[160:163], v[80:83], v[64:67], v[160:163]
    v_add_u32 v17, 0x10000, v17
    v_add_u32 v18, 0x10000, v18
    v_mfma_f32_16x16x32_bf16 v[168:171], v[80:83], v[68:71], v[168:171]
    v_add_u32 v15, 0x10000, v15
    v_mfma_f32_16x16x32_bf16 v[164:167], v[84:87], v[64:67], v[164:167]
    v_add_u32 v16, 0x10000, v16
    v_mfma_f32_16x16x32_bf16 v[172:175], v[84:87], v[68:71], v[172:175]
    ds_read_b64_tr_b16 v[48:49], v17 offset:16384
    ds_read_b64_tr_b16 v[50:51], v17 offset:16896
    v_mfma_f32_16x16x32_bf16 v[112:115], v[80:83], v[72:75], v[112:115]
    ds_read_b128 v[32:35], v15 offset:0
    v_mfma_f32_16x16x32_bf16 v[120:123], v[80:83], v[76:79], v[120:123]
    ds_read_b128 v[36:39], v15 offset:2048
    v_mfma_f32_16x16x32_bf16 v[116:119], v[84:87], v[72:75], v[116:119]
    ds_read_b64_tr_b16 v[52:53], v18 offset:16384
    ds_read_b64_tr_b16 v[54:55], v18 offset:16896
    v_mfma_f32_16x16x32_bf16 v[124:127], v[84:87], v[76:79], v[124:127]
    ds_read_b128 v[40:43], v15 offset:4096
    s_waitcnt lgkmcnt(7)
    v_mfma_f32_16x16x32_bf16 v[128:131], v[88:91], v[64:67], v[128:131]
    ds_read_b128 v[44:47], v15 offset:6144
    v_mfma_f32_16x16x32_bf16 v[136:139], v[88:91], v[68:71], v[136:139]
    ds_read_b64_tr_b16 v[56:57], v17 offset:24576
    ds_read_b64_tr_b16 v[58:59], v17 offset:25088
    v_mfma_f32_16x16x32_bf16 v[144:147], v[88:91], v[72:75], v[144:147]
    ds_read_b64_tr_b16 v[60:61], v18 offset:24576
    v_mfma_f32_16x16x32_bf16 v[152:155], v[88:91], v[76:79], v[152:155]
    ds_read_b64_tr_b16 v[62:63], v18 offset:25088
    v_mfma_f32_16x16x32_bf16 v[132:135], v[92:95], v[64:67], v[132:135]
    v_mfma_f32_16x16x32_bf16 v[140:143], v[92:95], v[68:71], v[140:143]
    v_mfma_f32_16x16x32_bf16 v[148:151], v[92:95], v[72:75], v[148:151]
    v_mfma_f32_16x16x32_bf16 v[156:159], v[92:95], v[76:79], v[156:159]
    s_waitcnt lgkmcnt(4)
    v_mfma_f32_16x16x32_bf16 v[160:163], v[48:51], v[32:35], v[160:163]
    ds_read_b64_tr_b16 v[80:81], v17 offset:20480
    ds_read_b64_tr_b16 v[82:83], v17 offset:20992
    v_mfma_f32_16x16x32_bf16 v[168:171], v[48:51], v[36:39], v[168:171]
    ds_read_b128 v[64:67], v16 offset:0
    v_mfma_f32_16x16x32_bf16 v[164:167], v[52:55], v[32:35], v[164:167]
    ds_read_b128 v[68:71], v16 offset:2048
    v_mfma_f32_16x16x32_bf16 v[172:175], v[52:55], v[36:39], v[172:175]
    ds_read_b64_tr_b16 v[84:85], v18 offset:20480
    v_mfma_f32_16x16x32_bf16 v[112:115], v[48:51], v[40:43], v[112:115]
    ds_read_b64_tr_b16 v[86:87], v18 offset:20992
    v_mfma_f32_16x16x32_bf16 v[120:123], v[48:51], v[44:47], v[120:123]
    ds_read_b128 v[72:75], v16 offset:4096
    v_mfma_f32_16x16x32_bf16 v[116:119], v[52:55], v[40:43], v[116:119]
    ds_read_b128 v[76:79], v16 offset:6144
    v_mfma_f32_16x16x32_bf16 v[124:127], v[52:55], v[44:47], v[124:127]
    ds_read_b64_tr_b16 v[88:89], v17 offset:28672
    s_waitcnt lgkmcnt(9)
    v_mfma_f32_16x16x32_bf16 v[128:131], v[56:59], v[32:35], v[128:131]
    ds_read_b64_tr_b16 v[90:91], v17 offset:29184
    v_mfma_f32_16x16x32_bf16 v[136:139], v[56:59], v[36:39], v[136:139]
    ds_read_b64_tr_b16 v[92:93], v18 offset:28672
    v_mfma_f32_16x16x32_bf16 v[144:147], v[56:59], v[40:43], v[144:147]
    ds_read_b64_tr_b16 v[94:95], v18 offset:29184
    v_mfma_f32_16x16x32_bf16 v[152:155], v[56:59], v[44:47], v[152:155]
    buffer_load_dword v4, off, s[28:31], 0 sc1
    v_mfma_f32_16x16x32_bf16 v[132:135], v[60:63], v[32:35], v[132:135]
    v_mfma_f32_16x16x32_bf16 v[140:143], v[60:63], v[36:39], v[140:143]
    v_mfma_f32_16x16x32_bf16 v[148:151], v[60:63], v[40:43], v[148:151]
    v_mfma_f32_16x16x32_bf16 v[156:159], v[60:63], v[44:47], v[156:159]
    s_barrier
    s_waitcnt lgkmcnt(4)
    v_mfma_f32_16x16x32_bf16 v[160:163], v[80:83], v[64:67], v[160:163]
    v_add_u32 v17, 0xfffe0000, v17
    v_add_u32 v18, 0xfffe0000, v18
    v_mfma_f32_16x16x32_bf16 v[168:171], v[80:83], v[68:71], v[168:171]
    v_add_u32 v15, 0xfffe0000, v15
    v_mfma_f32_16x16x32_bf16 v[164:167], v[84:87], v[64:67], v[164:167]
    v_add_u32 v16, 0xfffe0000, v16
    v_mfma_f32_16x16x32_bf16 v[172:175], v[84:87], v[68:71], v[172:175]
    ds_read_b64_tr_b16 v[48:49], v17 offset:16384
    ds_read_b64_tr_b16 v[50:51], v17 offset:16896
    v_mfma_f32_16x16x32_bf16 v[112:115], v[80:83], v[72:75], v[112:115]
    ds_read_b128 v[32:35], v15 offset:0
    v_mfma_f32_16x16x32_bf16 v[120:123], v[80:83], v[76:79], v[120:123]
    ds_read_b128 v[36:39], v15 offset:2048
    v_mfma_f32_16x16x32_bf16 v[116:119], v[84:87], v[72:75], v[116:119]
    ds_read_b64_tr_b16 v[52:53], v18 offset:16384
    ds_read_b64_tr_b16 v[54:55], v18 offset:16896
    v_mfma_f32_16x16x32_bf16 v[124:127], v[84:87], v[76:79], v[124:127]
    ds_read_b128 v[40:43], v15 offset:4096
    s_waitcnt lgkmcnt(7)
    v_mfma_f32_16x16x32_bf16 v[128:131], v[88:91], v[64:67], v[128:131]
    ds_read_b128 v[44:47], v15 offset:6144
    v_mfma_f32_16x16x32_bf16 v[136:139], v[88:91], v[68:71], v[136:139]
    ds_read_b64_tr_b16 v[56:57], v17 offset:24576
    ds_read_b64_tr_b16 v[58:59], v17 offset:25088
    v_mfma_f32_16x16x32_bf16 v[144:147], v[88:91], v[72:75], v[144:147]
    ds_read_b64_tr_b16 v[60:61], v18 offset:24576
    v_mfma_f32_16x16x32_bf16 v[152:155], v[88:91], v[76:79], v[152:155]
    ds_read_b64_tr_b16 v[62:63], v18 offset:25088
    v_mfma_f32_16x16x32_bf16 v[132:135], v[92:95], v[64:67], v[132:135]
    v_mfma_f32_16x16x32_bf16 v[140:143], v[92:95], v[68:71], v[140:143]
    v_mfma_f32_16x16x32_bf16 v[148:151], v[92:95], v[72:75], v[148:151]
    v_mfma_f32_16x16x32_bf16 v[156:159], v[92:95], v[76:79], v[156:159]
    s_waitcnt lgkmcnt(4)
    v_mfma_f32_16x16x32_bf16 v[160:163], v[48:51], v[32:35], v[160:163]
    ds_read_b64_tr_b16 v[80:81], v17 offset:20480
    v_mfma_f32_16x16x32_bf16 v[168:171], v[48:51], v[36:39], v[168:171]
    ds_read_b64_tr_b16 v[82:83], v17 offset:20992
    v_mfma_f32_16x16x32_bf16 v[164:167], v[52:55], v[32:35], v[164:167]
    ds_read_b128 v[64:67], v16 offset:0
    v_mfma_f32_16x16x32_bf16 v[172:175], v[52:55], v[36:39], v[172:175]
    ds_read_b128 v[68:71], v16 offset:2048
    v_mfma_f32_16x16x32_bf16 v[112:115], v[48:51], v[40:43], v[112:115]
    ds_read_b64_tr_b16 v[84:85], v18 offset:20480
    v_mfma_f32_16x16x32_bf16 v[120:123], v[48:51], v[44:47], v[120:123]
    ds_read_b64_tr_b16 v[86:87], v18 offset:20992
    v_mfma_f32_16x16x32_bf16 v[116:119], v[52:55], v[40:43], v[116:119]
    ds_read_b128 v[72:75], v16 offset:4096
    v_mfma_f32_16x16x32_bf16 v[124:127], v[52:55], v[44:47], v[124:127]
    ds_read_b128 v[76:79], v16 offset:6144
    s_waitcnt lgkmcnt(8)
    v_mfma_f32_16x16x32_bf16 v[128:131], v[56:59], v[32:35], v[128:131]
    ds_read_b64_tr_b16 v[88:89], v17 offset:28672
    v_mfma_f32_16x16x32_bf16 v[136:139], v[56:59], v[36:39], v[136:139]
    ds_read_b64_tr_b16 v[90:91], v17 offset:29184
    v_mfma_f32_16x16x32_bf16 v[144:147], v[56:59], v[40:43], v[144:147]
    ds_read_b64_tr_b16 v[92:93], v18 offset:28672
    v_mfma_f32_16x16x32_bf16 v[152:155], v[56:59], v[44:47], v[152:155]
    ds_read_b64_tr_b16 v[94:95], v18 offset:29184
    v_mfma_f32_16x16x32_bf16 v[132:135], v[60:63], v[32:35], v[132:135]
    v_mfma_f32_16x16x32_bf16 v[140:143], v[60:63], v[36:39], v[140:143]
    v_mfma_f32_16x16x32_bf16 v[148:151], v[60:63], v[40:43], v[148:151]
    v_mfma_f32_16x16x32_bf16 v[156:159], v[60:63], v[44:47], v[156:159]
    s_barrier
    s_waitcnt lgkmcnt(4)
    v_mfma_f32_16x16x32_bf16 v[160:163], v[80:83], v[64:67], v[160:163]
    ds_read_b64_tr_b16 v[48:49], v17 offset:49152
    v_mfma_f32_16x16x32_bf16 v[168:171], v[80:83], v[68:71], v[168:171]
    ds_read_b64_tr_b16 v[50:51], v17 offset:49664
    v_mfma_f32_16x16x32_bf16 v[164:167], v[84:87], v[64:67], v[164:167]
    ds_read_b128 v[32:35], v15 offset:32768
    v_mfma_f32_16x16x32_bf16 v[172:175], v[84:87], v[68:71], v[172:175]
    ds_read_b128 v[36:39], v15 offset:34816
    v_mfma_f32_16x16x32_bf16 v[112:115], v[80:83], v[72:75], v[112:115]
    ds_read_b64_tr_b16 v[52:53], v18 offset:49152
    v_mfma_f32_16x16x32_bf16 v[120:123], v[80:83], v[76:79], v[120:123]
    ds_read_b64_tr_b16 v[54:55], v18 offset:49664
    v_mfma_f32_16x16x32_bf16 v[116:119], v[84:87], v[72:75], v[116:119]
    ds_read_b128 v[40:43], v15 offset:36864
    v_mfma_f32_16x16x32_bf16 v[124:127], v[84:87], v[76:79], v[124:127]
    ds_read_b128 v[44:47], v15 offset:38912
    s_waitcnt lgkmcnt(8)
    v_mfma_f32_16x16x32_bf16 v[128:131], v[88:91], v[64:67], v[128:131]
    ds_read_b64_tr_b16 v[56:57], v17 offset:57344
    v_mfma_f32_16x16x32_bf16 v[136:139], v[88:91], v[68:71], v[136:139]
    ds_read_b64_tr_b16 v[58:59], v17 offset:57856
    v_mfma_f32_16x16x32_bf16 v[144:147], v[88:91], v[72:75], v[144:147]
    ds_read_b64_tr_b16 v[60:61], v18 offset:57344
    v_mfma_f32_16x16x32_bf16 v[152:155], v[88:91], v[76:79], v[152:155]
    ds_read_b64_tr_b16 v[62:63], v18 offset:57856
    v_mfma_f32_16x16x32_bf16 v[132:135], v[92:95], v[64:67], v[132:135]
    v_mfma_f32_16x16x32_bf16 v[140:143], v[92:95], v[68:71], v[140:143]
    v_mfma_f32_16x16x32_bf16 v[148:151], v[92:95], v[72:75], v[148:151]
    v_mfma_f32_16x16x32_bf16 v[156:159], v[92:95], v[76:79], v[156:159]
    s_waitcnt lgkmcnt(4)
    v_mfma_f32_16x16x32_bf16 v[160:163], v[48:51], v[32:35], v[160:163]
    ds_read_b64_tr_b16 v[80:81], v17 offset:53248
    ds_read_b64_tr_b16 v[82:83], v17 offset:53760
    v_mfma_f32_16x16x32_bf16 v[168:171], v[48:51], v[36:39], v[168:171]
    ds_read_b128 v[64:67], v16 offset:32768
    v_mfma_f32_16x16x32_bf16 v[164:167], v[52:55], v[32:35], v[164:167]
    ds_read_b128 v[68:71], v16 offset:34816
    v_mfma_f32_16x16x32_bf16 v[172:175], v[52:55], v[36:39], v[172:175]
    ds_read_b64_tr_b16 v[84:85], v18 offset:53248
    v_mfma_f32_16x16x32_bf16 v[112:115], v[48:51], v[40:43], v[112:115]
    ds_read_b64_tr_b16 v[86:87], v18 offset:53760
    v_mfma_f32_16x16x32_bf16 v[120:123], v[48:51], v[44:47], v[120:123]
    ds_read_b128 v[72:75], v16 offset:36864
    v_mfma_f32_16x16x32_bf16 v[116:119], v[52:55], v[40:43], v[116:119]
    ds_read_b128 v[76:79], v16 offset:38912
    ds_read_b64_tr_b16 v[88:89], v17 offset:61440
    v_mfma_f32_16x16x32_bf16 v[124:127], v[52:55], v[44:47], v[124:127]
    ds_read_b64_tr_b16 v[90:91], v17 offset:61952
    s_waitcnt lgkmcnt(10)
    v_mfma_f32_16x16x32_bf16 v[128:131], v[56:59], v[32:35], v[128:131]
    ds_read_b64_tr_b16 v[92:93], v18 offset:61440
    v_mfma_f32_16x16x32_bf16 v[136:139], v[56:59], v[36:39], v[136:139]
    ds_read_b64_tr_b16 v[94:95], v18 offset:61952
    v_mfma_f32_16x16x32_bf16 v[144:147], v[56:59], v[40:43], v[144:147]
    buffer_load_dword v10, v246, s[32:35], s66 offen
    v_mfma_f32_16x16x32_bf16 v[152:155], v[56:59], v[44:47], v[152:155]
    buffer_load_dword v11, v247, s[36:39], s68 offen
    v_mfma_f32_16x16x32_bf16 v[132:135], v[60:63], v[32:35], v[132:135]
    v_mfma_f32_16x16x32_bf16 v[140:143], v[60:63], v[36:39], v[140:143]
    v_mfma_f32_16x16x32_bf16 v[148:151], v[60:63], v[40:43], v[148:151]
    v_mfma_f32_16x16x32_bf16 v[156:159], v[60:63], v[44:47], v[156:159]
    s_barrier
    s_waitcnt lgkmcnt(4)
    v_mfma_f32_16x16x32_bf16 v[160:163], v[80:83], v[64:67], v[160:163]
    v_add_u32 v17, 0x10000, v17
    v_add_u32 v18, 0x10000, v18
    v_mfma_f32_16x16x32_bf16 v[168:171], v[80:83], v[68:71], v[168:171]
    v_add_u32 v15, 0x10000, v15
    v_mfma_f32_16x16x32_bf16 v[164:167], v[84:87], v[64:67], v[164:167]
    v_add_u32 v16, 0x10000, v16
    v_mfma_f32_16x16x32_bf16 v[172:175], v[84:87], v[68:71], v[172:175]
    ds_read_b64_tr_b16 v[48:49], v17 offset:16384
    ds_read_b64_tr_b16 v[50:51], v17 offset:16896
    v_mfma_f32_16x16x32_bf16 v[112:115], v[80:83], v[72:75], v[112:115]
    ds_read_b128 v[32:35], v15 offset:0
    v_mfma_f32_16x16x32_bf16 v[120:123], v[80:83], v[76:79], v[120:123]
    ds_read_b128 v[36:39], v15 offset:2048
    v_mfma_f32_16x16x32_bf16 v[116:119], v[84:87], v[72:75], v[116:119]
    ds_read_b64_tr_b16 v[52:53], v18 offset:16384
    ds_read_b64_tr_b16 v[54:55], v18 offset:16896
    v_mfma_f32_16x16x32_bf16 v[124:127], v[84:87], v[76:79], v[124:127]
    ds_read_b128 v[40:43], v15 offset:4096
    s_waitcnt lgkmcnt(7)
    v_mfma_f32_16x16x32_bf16 v[128:131], v[88:91], v[64:67], v[128:131]
    ds_read_b128 v[44:47], v15 offset:6144
    v_mfma_f32_16x16x32_bf16 v[136:139], v[88:91], v[68:71], v[136:139]
    ds_read_b64_tr_b16 v[56:57], v17 offset:24576
    ds_read_b64_tr_b16 v[58:59], v17 offset:25088
    v_mfma_f32_16x16x32_bf16 v[144:147], v[88:91], v[72:75], v[144:147]
    ds_read_b64_tr_b16 v[60:61], v18 offset:24576
    v_mfma_f32_16x16x32_bf16 v[152:155], v[88:91], v[76:79], v[152:155]
    ds_read_b64_tr_b16 v[62:63], v18 offset:25088
    v_mfma_f32_16x16x32_bf16 v[132:135], v[92:95], v[64:67], v[132:135]
    v_mfma_f32_16x16x32_bf16 v[140:143], v[92:95], v[68:71], v[140:143]
    v_mfma_f32_16x16x32_bf16 v[148:151], v[92:95], v[72:75], v[148:151]
    v_mfma_f32_16x16x32_bf16 v[156:159], v[92:95], v[76:79], v[156:159]
    s_waitcnt lgkmcnt(4)
    v_mfma_f32_16x16x32_bf16 v[160:163], v[48:51], v[32:35], v[160:163]
    ds_read_b64_tr_b16 v[80:81], v17 offset:20480
    v_mfma_f32_16x16x32_bf16 v[168:171], v[48:51], v[36:39], v[168:171]
    ds_read_b64_tr_b16 v[82:83], v17 offset:20992
    v_mfma_f32_16x16x32_bf16 v[164:167], v[52:55], v[32:35], v[164:167]
    ds_read_b128 v[64:67], v16 offset:0
    v_mfma_f32_16x16x32_bf16 v[172:175], v[52:55], v[36:39], v[172:175]
    ds_read_b128 v[68:71], v16 offset:2048
    v_mfma_f32_16x16x32_bf16 v[112:115], v[48:51], v[40:43], v[112:115]
    ds_read_b64_tr_b16 v[84:85], v18 offset:20480
    v_mfma_f32_16x16x32_bf16 v[120:123], v[48:51], v[44:47], v[120:123]
    ds_read_b64_tr_b16 v[86:87], v18 offset:20992
    v_mfma_f32_16x16x32_bf16 v[116:119], v[52:55], v[40:43], v[116:119]
    ds_read_b128 v[72:75], v16 offset:4096
    v_mfma_f32_16x16x32_bf16 v[124:127], v[52:55], v[44:47], v[124:127]
    ds_read_b128 v[76:79], v16 offset:6144
    s_waitcnt lgkmcnt(8)
    v_mfma_f32_16x16x32_bf16 v[128:131], v[56:59], v[32:35], v[128:131]
    ds_read_b64_tr_b16 v[88:89], v17 offset:28672
    v_mfma_f32_16x16x32_bf16 v[136:139], v[56:59], v[36:39], v[136:139]
    ds_read_b64_tr_b16 v[90:91], v17 offset:29184
    v_mfma_f32_16x16x32_bf16 v[144:147], v[56:59], v[40:43], v[144:147]
    ds_read_b64_tr_b16 v[92:93], v18 offset:28672
    v_mfma_f32_16x16x32_bf16 v[152:155], v[56:59], v[44:47], v[152:155]
    ds_read_b64_tr_b16 v[94:95], v18 offset:29184
    v_mfma_f32_16x16x32_bf16 v[132:135], v[60:63], v[32:35], v[132:135]
    v_mfma_f32_16x16x32_bf16 v[140:143], v[60:63], v[36:39], v[140:143]
    v_mfma_f32_16x16x32_bf16 v[148:151], v[60:63], v[40:43], v[148:151]
    v_mfma_f32_16x16x32_bf16 v[156:159], v[60:63], v[44:47], v[156:159]
    s_barrier
    s_waitcnt lgkmcnt(4)
    v_mfma_f32_16x16x32_bf16 v[160:163], v[80:83], v[64:67], v[160:163]
    v_mfma_f32_16x16x32_bf16 v[168:171], v[80:83], v[68:71], v[168:171]
    v_mfma_f32_16x16x32_bf16 v[164:167], v[84:87], v[64:67], v[164:167]
    v_mfma_f32_16x16x32_bf16 v[172:175], v[84:87], v[68:71], v[172:175]
    v_mfma_f32_16x16x32_bf16 v[112:115], v[80:83], v[72:75], v[112:115]
    v_mfma_f32_16x16x32_bf16 v[120:123], v[80:83], v[76:79], v[120:123]
    v_mfma_f32_16x16x32_bf16 v[116:119], v[84:87], v[72:75], v[116:119]
    v_mfma_f32_16x16x32_bf16 v[124:127], v[84:87], v[76:79], v[124:127]
    s_waitcnt lgkmcnt(0)
    v_mfma_f32_16x16x32_bf16 v[128:131], v[88:91], v[64:67], v[128:131]
    v_mfma_f32_16x16x32_bf16 v[136:139], v[88:91], v[68:71], v[136:139]
    v_mfma_f32_16x16x32_bf16 v[144:147], v[88:91], v[72:75], v[144:147]
    v_mfma_f32_16x16x32_bf16 v[152:155], v[88:91], v[76:79], v[152:155]
    v_mfma_f32_16x16x32_bf16 v[132:135], v[92:95], v[64:67], v[132:135]
    v_mfma_f32_16x16x32_bf16 v[140:143], v[92:95], v[68:71], v[140:143]
    v_mfma_f32_16x16x32_bf16 v[148:151], v[92:95], v[72:75], v[148:151]
    v_mfma_f32_16x16x32_bf16 v[156:159], v[92:95], v[76:79], v[156:159]
    s_setprio 0
    s_waitcnt vmcnt(2)
    v_cmp_eq_u32 vcc, 0, v4
    s_cbranch_vccnz L_slow20
L_back20:
    v_readfirstlane_b32 s61, v4
    s_cmp_eq_u32 s49, 3
    s_cselect_b32 s23, 0, s61
    s_lshl_b32 s62, s61, 1
    v_mul_f32 v240, v160, v160
    v_mul_f32 v241, v161, v161
    v_mul_f32 v242, v162, v162
    v_mul_f32 v243, v163, v163
    v_mul_f32 v244, v164, v164
    v_mul_f32 v245, v165, v165
    v_mul_f32 v246, v166, v166
    v_mul_f32 v247, v167, v167
    v_mul_f32 v248, v168, v168
    v_mul_f32 v249, v169, v169
    v_mul_f32 v250, v170, v170
    v_mul_f32 v251, v171, v171
    v_mul_f32 v252, v172, v172
    v_mul_f32 v253, v173, v173
    v_mul_f32 v254, v174, v174
    v_mul_f32 v255, v175, v175
    v_fma_f32 v240, v240, s64, v6
    v_fma_f32 v241, v241, s64, v6
    v_fma_f32 v242, v242, s64, v6
    v_fma_f32 v243, v243, s64, v6
    v_fma_f32 v244, v244, s64, v6
    v_fma_f32 v245, v245, s64, v6
    v_fma_f32 v246, v246, s64, v6
    v_fma_f32 v247, v247, s64, v6
    v_fma_f32 v248, v248, s64, v6
    v_fma_f32 v249, v249, s64, v6
    v_fma_f32 v250, v250, s64, v6
    v_fma_f32 v251, v251, s64, v6
    v_fma_f32 v252, v252, s64, v6
    v_fma_f32 v253, v253, s64, v6
    v_fma_f32 v254, v254, s64, v6
    v_fma_f32 v255, v255, s64, v6
    v_mul_f32 v240, v160, v240
    v_mul_f32 v241, v161, v241
    v_mul_f32 v242, v162, v242
    v_mul_f32 v243, v163, v243
    v_mul_f32 v244, v164, v244
    v_mul_f32 v245, v165, v245
    v_mul_f32 v246, v166, v246
    v_mul_f32 v247, v167, v247
    v_mul_f32 v248, v168, v248
    v_mul_f32 v249, v169, v249
    v_mul_f32 v250, v170, v250
    v_mul_f32 v251, v171, v251
    v_mul_f32 v252, v172, v252
    v_mul_f32 v253, v173, v253
    v_mul_f32 v254, v174, v254
    v_mul_f32 v255, v175, v255
    v_exp_f32 v240, v240
    v_exp_f32 v241, v241
    v_exp_f32 v242, v242
    v_exp_f32 v243, v243
    v_exp_f32 v244, v244
    v_exp_f32 v245, v245
    v_exp_f32 v246, v246
    v_exp_f32 v247, v247
    v_exp_f32 v248, v248
    v_exp_f32 v249, v249
    v_exp_f32 v250, v250
    v_exp_f32 v251, v251
    v_exp_f32 v252, v252
    v_exp_f32 v253, v253
    v_exp_f32 v254, v254
    v_exp_f32 v255, v255
    v_add_f32 v240, 1.0, v240
    v_add_f32 v241, 1.0, v241
    v_add_f32 v242, 1.0, v242
    v_add_f32 v243, 1.0, v243
    v_add_f32 v244, 1.0, v244
    v_add_f32 v245, 1.0, v245
    v_add_f32 v246, 1.0, v246
    v_add_f32 v247, 1.0, v247
    v_add_f32 v248, 1.0, v248
    v_add_f32 v249, 1.0, v249
    v_add_f32 v250, 1.0, v250
    v_add_f32 v251, 1.0, v251
    v_add_f32 v252, 1.0, v252
    v_add_f32 v253, 1.0, v253
    v_add_f32 v254, 1.0, v254
    v_add_f32 v255, 1.0, v255
    v_rcp_f32 v240, v240
    v_rcp_f32 v241, v241
    v_rcp_f32 v242, v242
    v_rcp_f32 v243, v243
    v_rcp_f32 v244, v244
    v_rcp_f32 v245, v245
    v_rcp_f32 v246, v246
    v_rcp_f32 v247, v247
    v_rcp_f32 v248, v248
    v_rcp_f32 v249, v249
    v_rcp_f32 v250, v250
    v_rcp_f32 v251, v251
    v_rcp_f32 v252, v252
    v_rcp_f32 v253, v253
    v_rcp_f32 v254, v254
    v_rcp_f32 v255, v255
    v_mul_f32 v240, v160, v240
    v_mul_f32 v241, v161, v241
    v_mul_f32 v242, v162, v242
    v_mul_f32 v243, v163, v243
    v_mul_f32 v244, v164, v244
    v_mul_f32 v245, v165, v245
    v_mul_f32 v246, v166, v246
    v_mul_f32 v247, v167, v247
    v_mul_f32 v248, v168, v248
    v_mul_f32 v249, v169, v249
    v_mul_f32 v250, v170, v250
    v_mul_f32 v251, v171, v251
    v_mul_f32 v252, v172, v252
    v_mul_f32 v253, v173, v253
    v_mul_f32 v254, v174, v254
    v_mul_f32 v255, v175, v255
    v_cvt_pk_bf16_f32 v176, v240, v241
    v_cvt_pk_bf16_f32 v177, v242, v243
    v_cvt_pk_bf16_f32 v178, v244, v245
    v_cvt_pk_bf16_f32 v179, v246, v247
    v_cvt_pk_bf16_f32 v180, v248, v249
    v_cvt_pk_bf16_f32 v181, v250, v251
    v_cvt_pk_bf16_f32 v182, v252, v253
    v_cvt_pk_bf16_f32 v183, v254, v255
    v_add3_u32 v208, v176, v177, v178
    buffer_store_dwordx4 v[176:179], v2, s[24:27], s87 offen offset:0 sc1
    v_add3_u32 v209, v179, v180, v181
    buffer_store_dwordx4 v[180:183], v2, s[24:27], s87 offen offset:1024 sc1
    v_add3_u32 v208, v208, v182, v183
    v_add_u32 v208, v208, v209
    v_sub_u32 v208, s61, v208
    buffer_store_dword v208, v12, s[24:27], s87 offen offset:0 sc1
    v_mul_f32 v240, v112, v112
    v_mul_f32 v241, v113, v113
    v_mul_f32 v242, v114, v114
    v_mul_f32 v243, v115, v115
    v_mul_f32 v244, v116, v116
    v_mul_f32 v245, v117, v117
    v_mul_f32 v246, v118, v118
    v_mul_f32 v247, v119, v119
    v_mul_f32 v248, v120, v120
    v_mul_f32 v249, v121, v121
    v_mul_f32 v250, v122, v122
    v_mul_f32 v251, v123, v123
    s_barrier
    ds_read_b64_tr_b16 v[32:33], v21 offset:0
    v_mul_f32 v252, v124, v124
    v_mul_f32 v253, v125, v125
    v_mul_f32 v254, v126, v126
    v_mul_f32 v255, v127, v127
    v_fma_f32 v240, v240, s64, v6
    v_fma_f32 v241, v241, s64, v6
    v_fma_f32 v242, v242, s64, v6
    v_fma_f32 v243, v243, s64, v6
    ds_read_b64_tr_b16 v[34:35], v21 offset:2048
    v_fma_f32 v244, v244, s64, v6
    v_fma_f32 v245, v245, s64, v6
    v_fma_f32 v246, v246, s64, v6
    v_fma_f32 v247, v247, s64, v6
    v_fma_f32 v248, v248, s64, v6
    v_fma_f32 v249, v249, s64, v6
    v_fma_f32 v250, v250, s64, v6
    v_fma_f32 v251, v251, s64, v6
    ds_read_b64_tr_b16 v[36:37], v22 offset:0
    v_fma_f32 v252, v252, s64, v6
    v_fma_f32 v253, v253, s64, v6
    v_fma_f32 v254, v254, s64, v6
    v_fma_f32 v255, v255, s64, v6
    v_mul_f32 v240, v112, v240
    v_mul_f32 v241, v113, v241
    v_mul_f32 v242, v114, v242
    v_mul_f32 v243, v115, v243
    ds_read_b64_tr_b16 v[38:39], v22 offset:2048
    v_mul_f32 v244, v116, v244
    v_mul_f32 v245, v117, v245
    v_mul_f32 v246, v118, v246
    v_mul_f32 v247, v119, v247
    v_mul_f32 v248, v120, v248
    v_mul_f32 v249, v121, v249
    v_mul_f32 v250, v122, v250
    v_mul_f32 v251, v123, v251
    v_mul_f32 v252, v124, v252
    ds_read_b64_tr_b16 v[40:41], v23 offset:0
    v_mul_f32 v253, v125, v253
    v_mul_f32 v254, v126, v254
    v_mul_f32 v255, v127, v255
    v_exp_f32 v240, v240
    v_exp_f32 v241, v241
    v_exp_f32 v242, v242
    v_exp_f32 v243, v243
    v_exp_f32 v244, v244
    ds_read_b64_tr_b16 v[42:43], v23 offset:2048
    v_exp_f32 v245, v245
    v_exp_f32 v246, v246
    v_exp_f32 v247, v247
    v_exp_f32 v248, v248
    v_exp_f32 v249, v249
    v_exp_f32 v250, v250
    v_exp_f32 v251, v251
    v_exp_f32 v252, v252
    ds_read_b64_tr_b16 v[44:45], v24 offset:0
    v_exp_f32 v253, v253
    v_exp_f32 v254, v254
    v_exp_f32 v255, v255
    v_add_f32 v240, 1.0, v240
    v_add_f32 v241, 1.0, v241
    v_add_f32 v242, 1.0, v242
    v_add_f32 v243, 1.0, v243
    v_add_f32 v244, 1.0, v244
    ds_read_b64_tr_b16 v[46:47], v24 offset:2048
    v_add_f32 v245, 1.0, v245
    v_add_f32 v246, 1.0, v246
    v_add_f32 v247, 1.0, v247
    v_add_f32 v248, 1.0, v248
    v_add_f32 v249, 1.0, v249
    v_add_f32 v250, 1.0, v250
    v_add_f32 v251, 1.0, v251
    v_add_f32 v252, 1.0, v252
    v_add_f32 v253, 1.0, v253
    ds_read_b64_tr_b16 v[48:49], v21 offset:16384
    v_add_f32 v254, 1.0, v254
    v_add_f32 v255, 1.0, v255
    v_rcp_f32 v240, v240
    v_rcp_f32 v241, v241
    v_rcp_f32 v242, v242
    v_rcp_f32 v243, v243
    v_rcp_f32 v244, v244
    v_rcp_f32 v245, v245
    ds_read_b64_tr_b16 v[50:51], v21 offset:18432
    v_rcp_f32 v246, v246
    v_rcp_f32 v247, v247
    v_rcp_f32 v248, v248
    v_rcp_f32 v249, v249
    v_rcp_f32 v250, v250
    v_rcp_f32 v251, v251
    v_rcp_f32 v252, v252
    v_rcp_f32 v253, v253
    ds_read_b64_tr_b16 v[52:53], v22 offset:16384
    v_rcp_f32 v254, v254
    v_rcp_f32 v255, v255
    v_mul_f32 v240, v112, v240
    v_mul_f32 v241, v113, v241
    v_mul_f32 v242, v114, v242
    v_mul_f32 v243, v115, v243
    v_mul_f32 v244, v116, v244
    v_mul_f32 v245, v117, v245
    ds_read_b64_tr_b16 v[54:55], v22 offset:18432
    v_mul_f32 v246, v118, v246
    v_mul_f32 v247, v119, v247
    v_mul_f32 v248, v120, v248
    v_mul_f32 v249, v121, v249
    v_mul_f32 v250, v122, v250
    v_mul_f32 v251, v123, v251
    v_mul_f32 v252, v124, v252
    v_mul_f32 v253, v125, v253
    v_mul_f32 v254, v126, v254
    ds_read_b64_tr_b16 v[56:57], v23 offset:16384
    v_mul_f32 v255, v127, v255
    v_cvt_pk_bf16_f32 v184, v240, v241
    v_cvt_pk_bf16_f32 v185, v242, v243
    v_cvt_pk_bf16_f32 v186, v244, v245
    v_cvt_pk_bf16_f32 v187, v246, v247
    v_cvt_pk_bf16_f32 v188, v248, v249
    v_cvt_pk_bf16_f32 v189, v250, v251
    v_cvt_pk_bf16_f32 v190, v252, v253
    ds_read_b64_tr_b16 v[58:59], v23 offset:18432
    v_cvt_pk_bf16_f32 v191, v254, v255
    v_add3_u32 v210, v184, v185, v186
    buffer_store_dwordx4 v[184:187], v2, s[24:27], s88 offen offset:0 sc1
    v_add3_u32 v211, v187, v188, v189
    buffer_store_dwordx4 v[188:191], v2, s[24:27], s88 offen offset:1024 sc1
    v_add3_u32 v210, v210, v190, v191
    v_add_u32 v210, v210, v211
    v_sub_u32 v210, s61, v210
    ds_read_b64_tr_b16 v[60:61], v24 offset:16384
    buffer_store_dword v210, v5, s[24:27], s88 offen offset:0 sc1
    v_mul_f32 v240, v128, v128
    v_mul_f32 v241, v129, v129
    v_mul_f32 v242, v130, v130
    v_mul_f32 v243, v131, v131
    v_mul_f32 v244, v132, v132
    v_mul_f32 v245, v133, v133
    v_mul_f32 v246, v134, v134
    ds_read_b64_tr_b16 v[62:63], v24 offset:18432
    v_mul_f32 v247, v135, v135
    v_mul_f32 v248, v136, v136
    v_mul_f32 v249, v137, v137
    v_mul_f32 v250, v138, v138
    v_mul_f32 v251, v139, v139
    v_mul_f32 v252, v140, v140
    v_mul_f32 v253, v141, v141
    v_mul_f32 v254, v142, v142
    v_mul_f32 v255, v143, v143
    s_waitcnt lgkmcnt(0)
    s_barrier
    ds_read_b64_tr_b16 v[64:65], v21 offset:32768
    v_fma_f32 v240, v240, s64, v6
    v_fma_f32 v241, v241, s64, v6
    v_fma_f32 v242, v242, s64, v6
    v_fma_f32 v243, v243, s64, v6
    v_fma_f32 v244, v244, s64, v6
    v_fma_f32 v245, v245, s64, v6
    v_fma_f32 v246, v246, s64, v6
    v_fma_f32 v247, v247, s64, v6
    ds_read_b64_tr_b16 v[66:67], v21 offset:34816
    v_fma_f32 v248, v248, s64, v6
    v_fma_f32 v249, v249, s64, v6
    v_fma_f32 v250, v250, s64, v6
    v_fma_f32 v251, v251, s64, v6
    v_fma_f32 v252, v252, s64, v6
    v_fma_f32 v253, v253, s64, v6
    v_fma_f32 v254, v254, s64, v6
    v_fma_f32 v255, v255, s64, v6
    ds_read_b64_tr_b16 v[68:69], v22 offset:32768
    v_mul_f32 v240, v128, v240
    v_mul_f32 v241, v129, v241
    v_mul_f32 v242, v130, v242
    v_mul_f32 v243, v131, v243
    v_mul_f32 v244, v132, v244
    v_mul_f32 v245, v133, v245
    v_mul_f32 v246, v134, v246
    v_mul_f32 v247, v135, v247
    ds_read_b64_tr_b16 v[70:71], v22 offset:34816
    v_mul_f32 v248, v136, v248
    v_mul_f32 v249, v137, v249
    v_mul_f32 v250, v138, v250
    v_mul_f32 v251, v139, v251
    v_mul_f32 v252, v140, v252
    v_mul_f32 v253, v141, v253
    v_mul_f32 v254, v142, v254
    v_mul_f32 v255, v143, v255
    v_exp_f32 v240, v240
    ds_read_b64_tr_b16 v[72:73], v23 offset:32768
    v_exp_f32 v241, v241
    v_exp_f32 v242, v242
    v_exp_f32 v243, v243
    v_exp_f32 v244, v244
    v_exp_f32 v245, v245
    v_exp_f32 v246, v246
    v_exp_f32 v247, v247
    v_exp_f32 v248, v248
    ds_read_b64_tr_b16 v[74:75], v23 offset:34816
    v_exp_f32 v249, v249
    v_exp_f32 v250, v250
    v_exp_f32 v251, v251
    v_exp_f32 v252, v252
    v_exp_f32 v253, v253
    v_exp_f32 v254, v254
    v_exp_f32 v255, v255
    v_add_f32 v240, 1.0, v240
    ds_read_b64_tr_b16 v[76:77], v24 offset:32768
    v_add_f32 v241, 1.0, v241
    v_add_f32 v242, 1.0, v242
    v_add_f32 v243, 1.0, v243
    v_add_f32 v244, 1.0, v244
    v_add_f32 v245, 1.0, v245
    v_add_f32 v246, 1.0, v246
    v_add_f32 v247, 1.0, v247
    v_add_f32 v248, 1.0, v248
    ds_read_b64_tr_b16 v[78:79], v24 offset:34816
    v_add_f32 v249, 1.0, v249
    v_add_f32 v250, 1.0, v250
    v_add_f32 v251, 1.0, v251
    v_add_f32 v252, 1.0, v252
    v_add_f32 v253, 1.0, v253
    v_add_f32 v254, 1.0, v254
    v_add_f32 v255, 1.0, v255
    v_rcp_f32 v240, v240
    v_rcp_f32 v241, v241
    ds_read_b64_tr_b16 v[80:81], v21 offset:49152
    v_rcp_f32 v242, v242
    v_rcp_f32 v243, v243
    v_rcp_f32 v244, v244
    v_rcp_f32 v245, v245
    v_rcp_f32 v246, v246
    v_rcp_f32 v247, v247
    v_rcp_f32 v248, v248
    v_rcp_f32 v249, v249
    ds_read_b64_tr_b16 v[82:83], v21 offset:51200
    v_rcp_f32 v250, v250
    v_rcp_f32 v251, v251
    v_rcp_f32 v252, v252
    v_rcp_f32 v253, v253
    v_rcp_f32 v254, v254
    v_rcp_f32 v255, v255
    v_mul_f32 v240, v128, v240
    v_mul_f32 v241, v129, v241
    ds_read_b64_tr_b16 v[84:85], v22 offset:49152
    v_mul_f32 v242, v130, v242
    v_mul_f32 v243, v131, v243
    v_mul_f32 v244, v132, v244
    v_mul_f32 v245, v133, v245
    v_mul_f32 v246, v134, v246
    v_mul_f32 v247, v135, v247
    v_mul_f32 v248, v136, v248
    v_mul_f32 v249, v137, v249
    ds_read_b64_tr_b16 v[86:87], v22 offset:51200
    v_mul_f32 v250, v138, v250
    v_mul_f32 v251, v139, v251
    v_mul_f32 v252, v140, v252
    v_mul_f32 v253, v141, v253
    v_mul_f32 v254, v142, v254
    v_mul_f32 v255, v143, v255
    v_cvt_pk_bf16_f32 v192, v240, v241
    v_cvt_pk_bf16_f32 v193, v242, v243
    v_cvt_pk_bf16_f32 v194, v244, v245
    ds_read_b64_tr_b16 v[88:89], v23 offset:49152
    v_cvt_pk_bf16_f32 v195, v246, v247
    v_cvt_pk_bf16_f32 v196, v248, v249
    v_cvt_pk_bf16_f32 v197, v250, v251
    v_cvt_pk_bf16_f32 v198, v252, v253
    v_cvt_pk_bf16_f32 v199, v254, v255
    v_add3_u32 v212, v192, v193, v194
    buffer_store_dwordx4 v[192:195], v2, s[24:27], s89 offen offset:0 sc1
    v_add3_u32 v213, v195, v196, v197
    ds_read_b64_tr_b16 v[90:91], v23 offset:51200
    buffer_store_dwordx4 v[196:199], v2, s[24:27], s89 offen offset:1024 sc1
    v_add3_u32 v212, v212, v198, v199
    v_add_u32 v212, v212, v213
    v_sub_u32 v212, s61, v212
    buffer_store_dword v212, v12, s[24:27], s89 offen offset:0 sc1
    v_mul_f32 v240, v144, v144
    v_mul_f32 v241, v145, v145
    v_mul_f32 v242, v146, v146
    ds_read_b64_tr_b16 v[92:93], v24 offset:49152
    v_mul_f32 v243, v147, v147
    v_mul_f32 v244, v148, v148
    v_mul_f32 v245, v149, v149
    v_mul_f32 v246, v150, v150
    v_mul_f32 v247, v151, v151
    v_mul_f32 v248, v152, v152
    v_mul_f32 v249, v153, v153
    v_mul_f32 v250, v154, v154
    ds_read_b64_tr_b16 v[94:95], v24 offset:51200
    v_mul_f32 v251, v155, v155
    v_mul_f32 v252, v156, v156
    v_mul_f32 v253, v157, v157
    v_mul_f32 v254, v158, v158
    v_mul_f32 v255, v159, v159
    v_fma_f32 v240, v240, s64, v6
    v_fma_f32 v241, v241, s64, v6
    v_fma_f32 v242, v242, s64, v6
    v_fma_f32 v243, v243, s64, v6
    s_waitcnt lgkmcnt(0)
    s_barrier
    v_add_u32 v21, 0x10000, v21
    v_fma_f32 v244, v244, s64, v6
    v_fma_f32 v245, v245, s64, v6
    v_fma_f32 v246, v246, s64, v6
    v_fma_f32 v247, v247, s64, v6
    v_fma_f32 v248, v248, s64, v6
    v_fma_f32 v249, v249, s64, v6
    v_fma_f32 v250, v250, s64, v6
    v_fma_f32 v251, v251, s64, v6
    v_fma_f32 v252, v252, s64, v6
    v_add_u32 v22, 0x10000, v22
    v_fma_f32 v253, v253, s64, v6
    v_fma_f32 v254, v254, s64, v6
    v_fma_f32 v255, v255, s64, v6
    v_mul_f32 v240, v144, v240
    v_mul_f32 v241, v145, v241
    v_mul_f32 v242, v146, v242
    v_mul_f32 v243, v147, v243
    v_mul_f32 v244, v148, v244
    v_mul_f32 v245, v149, v245
    v_add_u32 v23, 0x10000, v23
    v_mul_f32 v246, v150, v246
    v_mul_f32 v247, v151, v247
    v_mul_f32 v248, v152, v248
    v_mul_f32 v249, v153, v249
    v_mul_f32 v250, v154, v250
    v_mul_f32 v251, v155, v251
    v_mul_f32 v252, v156, v252
    v_mul_f32 v253, v157, v253
    v_mul_f32 v254, v158, v254
    v_add_u32 v24, 0x10000, v24
    v_mul_f32 v255, v159, v255
    v_exp_f32 v240, v240
    v_exp_f32 v241, v241
    v_exp_f32 v242, v242
    v_exp_f32 v243, v243
    v_exp_f32 v244, v244
    v_exp_f32 v245, v245
    v_exp_f32 v246, v246
    v_exp_f32 v247, v247
    ds_read_b64_tr_b16 v[96:97], v21 offset:0
    v_exp_f32 v248, v248
    v_exp_f32 v249, v249
    v_exp_f32 v250, v250
    v_exp_f32 v251, v251
    v_exp_f32 v252, v252
    v_exp_f32 v253, v253
    v_exp_f32 v254, v254
    v_exp_f32 v255, v255
    v_add_f32 v240, 1.0, v240
    ds_read_b64_tr_b16 v[98:99], v21 offset:2048
    v_add_f32 v241, 1.0, v241
    v_add_f32 v242, 1.0, v242
    v_add_f32 v243, 1.0, v243
    v_add_f32 v244, 1.0, v244
    v_add_f32 v245, 1.0, v245
    v_add_f32 v246, 1.0, v246
    v_add_f32 v247, 1.0, v247
    v_add_f32 v248, 1.0, v248
    v_add_f32 v249, 1.0, v249
    ds_read_b64_tr_b16 v[100:101], v22 offset:0
    v_add_f32 v250, 1.0, v250
    v_add_f32 v251, 1.0, v251
    v_add_f32 v252, 1.0, v252
    v_add_f32 v253, 1.0, v253
    v_add_f32 v254, 1.0, v254
    v_add_f32 v255, 1.0, v255
    v_rcp_f32 v240, v240
    v_rcp_f32 v241, v241
    v_rcp_f32 v242, v242
    ds_read_b64_tr_b16 v[102:103], v22 offset:2048
    v_rcp_f32 v243, v243
    v_rcp_f32 v244, v244
    v_rcp_f32 v245, v245
    v_rcp_f32 v246, v246
    v_rcp_f32 v247, v247
    v_rcp_f32 v248, v248
    v_rcp_f32 v249, v249
    v_rcp_f32 v250, v250
    v_rcp_f32 v251, v251
    ds_read_b64_tr_b16 v[104:105], v23 offset:0
    v_rcp_f32 v252, v252
    v_rcp_f32 v253, v253
    v_rcp_f32 v254, v254
    v_rcp_f32 v255, v255
    v_mul_f32 v240, v144, v240
    v_mul_f32 v241, v145, v241
    v_mul_f32 v242, v146, v242
    v_mul_f32 v243, v147, v243
    v_mul_f32 v244, v148, v244
    ds_read_b64_tr_b16 v[106:107], v23 offset:2048
    v_mul_f32 v245, v149, v245
    v_mul_f32 v246, v150, v246
    v_mul_f32 v247, v151, v247
    v_mul_f32 v248, v152, v248
    v_mul_f32 v249, v153, v249
    v_mul_f32 v250, v154, v250
    v_mul_f32 v251, v155, v251
    v_mul_f32 v252, v156, v252
    v_mul_f32 v253, v157, v253
    ds_read_b64_tr_b16 v[108:109], v24 offset:0
    v_mul_f32 v254, v158, v254
    v_mul_f32 v255, v159, v255
    v_cvt_pk_bf16_f32 v200, v240, v241
    v_cvt_pk_bf16_f32 v201, v242, v243
    v_cvt_pk_bf16_f32 v202, v244, v245
    v_cvt_pk_bf16_f32 v203, v246, v247
    v_cvt_pk_bf16_f32 v204, v248, v249
    v_cvt_pk_bf16_f32 v205, v250, v251
    v_cvt_pk_bf16_f32 v206, v252, v253
    ds_read_b64_tr_b16 v[110:111], v24 offset:2048
    v_cvt_pk_bf16_f32 v207, v254, v255
    v_add3_u32 v214, v200, v201, v202
    buffer_store_dwordx4 v[200:203], v2, s[24:27], s90 offen offset:0 sc1
    v_add3_u32 v215, v203, v204, v205
    buffer_store_dwordx4 v[204:207], v2, s[24:27], s90 offen offset:1024 sc1
    v_add3_u32 v214, v214, v206, v207
    v_add_u32 v214, v214, v215
    v_sub_u32 v214, s61, v214
    buffer_store_dword v214, v5, s[24:27], s90 offen offset:0 sc1
    s_waitcnt lgkmcnt(0)
    s_barrier
    s_setprio 0
    buffer_load_dwordx4 v[112:115], v25, s[24:27], s72 offen sc1
    buffer_load_dwordx4 v[116:119], v26, s[24:27], s72 offen sc1
    buffer_load_dword v160, v27, s[24:27], s72 offen sc1
    buffer_load_dwordx4 v[120:123], v25, s[24:27], s73 offen sc1
    buffer_load_dwordx4 v[124:127], v26, s[24:27], s73 offen sc1
    buffer_load_dword v161, v27, s[24:27], s73 offen sc1
    buffer_load_dwordx4 v[128:131], v25, s[24:27], s74 offen sc1
    buffer_load_dwordx4 v[132:135], v26, s[24:27], s74 offen sc1
    buffer_load_dword v162, v27, s[24:27], s74 offen sc1
L_P2_0:
    s_nop 1
    s_setprio 0
    s_add_u32 m0, s55, 147456
    s_lshl4_add_u32 s70, s85, 0xffea0000
    buffer_load_dwordx4 v13, s[36:39], s70 offen lds
    s_add_u32 m0, s55, 148480
    s_nop 0
    buffer_load_dwordx4 v14, s[36:39], s70 offen lds
    s_add_u32 m0, s55, 149504
    s_add_u32 s70, s70, 0x4000
    buffer_load_dwordx4 v13, s[36:39], s70 offen lds
    s_add_u32 m0, s55, 150528
    s_nop 0
    buffer_load_dwordx4 v14, s[36:39], s70 offen lds
    s_waitcnt vmcnt(10)
    v_add3_u32 v248, v160, v112, v113
    v_add3_u32 v249, v114, v115, v116
    v_add3_u32 v248, v248, v117, v118
    v_add3_u32 v248, v248, v249, v119
    v_cmp_ne_u32 vcc, s61, v248
    s_cbranch_vccnz L_slow21
L_back21:
    v_mfma_f32_16x16x32_bf16 v[184:187], v[32:35], v[116:119], 0
    v_and_b32 v243, 0xffff0000, v29
    v_lshlrev_b32 v242, 16, v29
    v_and_b32 v241, 0xffff0000, v28
    v_lshlrev_b32 v240, 16, v28
    v_and_b32 v247, 0xffff0000, v31
    v_mfma_f32_16x16x32_bf16 v[188:191], v[36:39], v[116:119], 0
    v_lshlrev_b32 v246, 16, v31
    v_and_b32 v245, 0xffff0000, v30
    v_lshlrev_b32 v244, 16, v30
    ds_read_b64_tr_b16 v[224:225], v21 offset:16384
    v_mfma_f32_16x16x32_bf16 v[192:195], v[40:43], v[112:115], 0
    ds_read_b64_tr_b16 v[226:227], v21 offset:18432
    ds_read_b64_tr_b16 v[228:229], v22 offset:16384
    ds_read_b64_tr_b16 v[230:231], v22 offset:18432
    ds_read_b64_tr_b16 v[232:233], v23 offset:16384
    ds_read_b64_tr_b16 v[234:235], v23 offset:18432
    v_mfma_f32_16x16x32_bf16 v[196:199], v[44:47], v[112:115], 0
    ds_read_b64_tr_b16 v[236:237], v24 offset:16384
    ds_read_b64_tr_b16 v[238:239], v24 offset:18432
    v_mfma_f32_16x16x32_bf16 v[200:203], v[40:43], v[116:119], 0
    v_mfma_f32_16x16x32_bf16 v[204:207], v[44:47], v[116:119], 0
    v_mfma_f32_16x16x32_bf16 v[176:179], v[32:35], v[112:115], v[240:243]
    s_waitcnt vmcnt(7)
    v_add3_u32 v248, v161, v120, v121
    v_add3_u32 v249, v122, v123, v124
    v_mfma_f32_16x16x32_bf16 v[180:183], v[36:39], v[112:115], v[244:247]
    v_add3_u32 v248, v248, v125, v126
    v_add3_u32 v248, v248, v249, v127
    v_cmp_ne_u32 vcc, s61, v248
    s_cbranch_vccnz L_slow22
L_back22:
    v_mfma_f32_16x16x32_bf16 v[184:187], v[48:51], v[124:127], v[184:187]
    buffer_load_dwordx4 v[136:139], v25, s[24:27], s75 offen sc1
    buffer_load_dwordx4 v[140:143], v26, s[24:27], s75 offen sc1
    buffer_load_dword v163, v27, s[24:27], s75 offen sc1
    s_add_u32 m0, s55, 65536
    s_lshl4_add_u32 s70, s86, 0xffea0000
    buffer_load_dwordx4 v13, s[36:39], s70 offen lds
    s_add_u32 m0, s55, 66560
    s_nop 0
    buffer_load_dwordx4 v14, s[36:39], s70 offen lds
    v_mfma_f32_16x16x32_bf16 v[188:191], v[52:55], v[124:127], v[188:191]
    s_add_u32 m0, s55, 67584
    s_add_u32 s70, s70, 0x4000
    buffer_load_dwordx4 v13, s[36:39], s70 offen lds
    s_add_u32 m0, s55, 68608
    s_nop 0
    buffer_load_dwordx4 v14, s[36:39], s70 offen lds
    ds_read_b64_tr_b16 v[208:209], v21 offset:32768
    ds_read_b64_tr_b16 v[210:211], v21 offset:34816
    v_mfma_f32_16x16x32_bf16 v[192:195], v[56:59], v[120:123], v[192:195]
    ds_read_b64_tr_b16 v[212:213], v22 offset:32768
    ds_read_b64_tr_b16 v[214:215], v22 offset:34816
    ds_read_b64_tr_b16 v[216:217], v23 offset:32768
    ds_read_b64_tr_b16 v[218:219], v23 offset:34816
    ds_read_b64_tr_b16 v[220:221], v24 offset:32768
    v_mfma_f32_16x16x32_bf16 v[196:199], v[60:63], v[120:123], v[196:199]
    ds_read_b64_tr_b16 v[222:223], v24 offset:34816
    v_mfma_f32_16x16x32_bf16 v[200:203], v[56:59], v[124:127], v[200:203]
    v_mfma_f32_16x16x32_bf16 v[204:207], v[60:63], v[124:127], v[204:207]
    v_mfma_f32_16x16x32_bf16 v[176:179], v[48:51], v[120:123], v[176:179]
    s_waitcnt vmcnt(11)
    v_add3_u32 v248, v162, v128, v129
    v_add3_u32 v249, v130, v131, v132
    v_mfma_f32_16x16x32_bf16 v[180:183], v[52:55], v[120:123], v[180:183]
    v_add3_u32 v248, v248, v133, v134
    v_add3_u32 v248, v248, v249, v135
    v_cmp_ne_u32 vcc, s61, v248
    s_cbranch_vccnz L_slow23
L_back23:
    v_mfma_f32_16x16x32_bf16 v[184:187], v[64:67], v[132:135], v[184:187]
    buffer_load_dwordx4 v[144:147], v25, s[24:27], s76 offen sc1
    buffer_load_dwordx4 v[148:151], v26, s[24:27], s76 offen sc1
    buffer_load_dword v164, v27, s[24:27], s76 offen sc1
    ds_read_b64_tr_b16 v[112:113], v21 offset:49152
    ds_read_b64_tr_b16 v[114:115], v21 offset:51200
    v_mfma_f32_16x16x32_bf16 v[188:191], v[68:71], v[132:135], v[188:191]
    ds_read_b64_tr_b16 v[116:117], v22 offset:49152
    ds_read_b64_tr_b16 v[118:119], v22 offset:51200
    ds_read_b64_tr_b16 v[120:121], v23 offset:49152
    ds_read_b64_tr_b16 v[122:123], v23 offset:51200
    v_mfma_f32_16x16x32_bf16 v[192:195], v[72:75], v[128:131], v[192:195]
    ds_read_b64_tr_b16 v[124:125], v24 offset:49152
    ds_read_b64_tr_b16 v[126:127], v24 offset:51200
    v_mfma_f32_16x16x32_bf16 v[196:199], v[76:79], v[128:131], v[196:199]
    v_mfma_f32_16x16x32_bf16 v[200:203], v[72:75], v[132:135], v[200:203]
    v_mfma_f32_16x16x32_bf16 v[204:207], v[76:79], v[132:135], v[204:207]
    v_mfma_f32_16x16x32_bf16 v[176:179], v[64:67], v[128:131], v[176:179]
    s_waitcnt vmcnt(7)
    v_add3_u32 v248, v163, v136, v137
    v_add3_u32 v249, v138, v139, v140
    v_mfma_f32_16x16x32_bf16 v[180:183], v[68:71], v[128:131], v[180:183]
    v_add3_u32 v248, v248, v141, v142
    v_add3_u32 v248, v248, v249, v143
    v_cmp_ne_u32 vcc, s61, v248
    s_cbranch_vccnz L_slow24
L_back24:
    v_mfma_f32_16x16x32_bf16 v[184:187], v[80:83], v[140:143], v[184:187]
    buffer_load_dwordx4 v[152:155], v25, s[24:27], s77 offen sc1
    buffer_load_dwordx4 v[156:159], v26, s[24:27], s77 offen sc1
    buffer_load_dword v165, v27, s[24:27], s77 offen sc1
    s_lshl1_add_u32 s66, s57, 0
    s_lshl_b32 s93, s66, 8
    v_mfma_f32_16x16x32_bf16 v[188:191], v[84:87], v[140:143], v[188:191]
    s_add_u32 s93, s93, 9437184
    s_and_b32 s67, s49, 1
    s_lshl_b32 s68, s67, 7
    v_and_b32 v3, 15, v1
    v_mfma_f32_16x16x32_bf16 v[192:195], v[88:91], v[136:139], v[192:195]
    v_lshlrev_b32 v4, 3, v3
    v_add_u32 v4, s68, v4
    v_xor_b32 v5, 0x80, v4
    buffer_load_dwordx2 v[252:253], v4, s[24:27], s93 offen sc1
    buffer_load_dwordx2 v[254:255], v5, s[24:27], s93 offen sc1
    v_mfma_f32_16x16x32_bf16 v[196:199], v[92:95], v[136:139], v[196:199]
    v_mfma_f32_16x16x32_bf16 v[200:203], v[88:91], v[140:143], v[200:203]
    v_mfma_f32_16x16x32_bf16 v[204:207], v[92:95], v[140:143], v[204:207]
    v_mfma_f32_16x16x32_bf16 v[176:179], v[80:83], v[136:139], v[176:179]
    s_waitcnt vmcnt(5)
    v_add3_u32 v248, v164, v144, v145
    v_add3_u32 v249, v146, v147, v148
    v_mfma_f32_16x16x32_bf16 v[180:183], v[84:87], v[136:139], v[180:183]
    v_add3_u32 v248, v248, v149, v150
    v_add3_u32 v248, v248, v249, v151
    v_cmp_ne_u32 vcc, s61, v248
    s_cbranch_vccnz L_slow25
L_back25:
    v_mfma_f32_16x16x32_bf16 v[184:187], v[96:99], v[148:151], v[184:187]
    buffer_load_dwordx4 v[32:35], v25, s[24:27], s78 offen sc1
    buffer_load_dwordx4 v[36:39], v26, s[24:27], s78 offen sc1
    buffer_load_dword v166, v27, s[24:27], s78 offen sc1
    s_lshl1_add_u32 s66, s66, s67
    s_lshl_b32 s71, s66, 14
    v_mfma_f32_16x16x32_bf16 v[188:191], v[100:103], v[148:151], v[188:191]
    s_lshl_b32 s66, s58, 7
    s_add_u32 s71, s71, s66
    s_and_b32 s66, s49, 2
    s_lshl_b32 s66, s66, 5
    v_mfma_f32_16x16x32_bf16 v[192:195], v[104:107], v[144:147], v[192:195]
    s_add_u32 s71, s71, s66
    v_lshlrev_b32 v3, 10, v3
    v_and_b32 v6, 16, v1
    v_lshl_add_u32 v3, v6, 1, v3
    v_lshrrev_b32 v6, 5, v1
    v_mfma_f32_16x16x32_bf16 v[196:199], v[108:111], v[144:147], v[196:199]
    v_lshl_add_u32 v3, v6, 4, v3
    v_mfma_f32_16x16x32_bf16 v[200:203], v[104:107], v[148:151], v[200:203]
    v_mfma_f32_16x16x32_bf16 v[204:207], v[108:111], v[148:151], v[204:207]
    v_mfma_f32_16x16x32_bf16 v[176:179], v[96:99], v[144:147], v[176:179]
    s_waitcnt vmcnt(5)
    v_add3_u32 v248, v165, v152, v153
    v_add3_u32 v249, v154, v155, v156
    v_mfma_f32_16x16x32_bf16 v[180:183], v[100:103], v[144:147], v[180:183]
    v_add3_u32 v248, v248, v157, v158
    v_add3_u32 v248, v248, v249, v159
    v_cmp_ne_u32 vcc, s61, v248
    s_cbranch_vccnz L_slow26
L_back26:
    s_waitcnt lgkmcnt(0)
    s_barrier
    v_mfma_f32_16x16x32_bf16 v[184:187], v[224:227], v[156:159], v[184:187]
    buffer_load_dwordx4 v[40:43], v25, s[24:27], s79 offen sc1
    buffer_load_dwordx4 v[44:47], v26, s[24:27], s79 offen sc1
    buffer_load_dword v167, v27, s[24:27], s79 offen sc1
    v_add_u32 v21, 0xffff0000, v21
    v_add_u32 v22, 0xffff0000, v22
    v_mfma_f32_16x16x32_bf16 v[188:191], v[228:231], v[156:159], v[188:191]
    v_add_u32 v23, 0xffff0000, v23
    v_add_u32 v24, 0xffff0000, v24
    ds_read_b64_tr_b16 v[128:129], v21 offset:0
    ds_read_b64_tr_b16 v[130:131], v21 offset:2048
    v_mfma_f32_16x16x32_bf16 v[192:195], v[232:235], v[152:155], v[192:195]
    ds_read_b64_tr_b16 v[132:133], v22 offset:0
    ds_read_b64_tr_b16 v[134:135], v22 offset:2048
    ds_read_b64_tr_b16 v[136:137], v23 offset:0
    ds_read_b64_tr_b16 v[138:139], v23 offset:2048
    ds_read_b64_tr_b16 v[140:141], v24 offset:0
    v_mfma_f32_16x16x32_bf16 v[196:199], v[236:239], v[152:155], v[196:199]
    ds_read_b64_tr_b16 v[142:143], v24 offset:2048
    v_mfma_f32_16x16x32_bf16 v[200:203], v[232:235], v[156:159], v[200:203]
    v_mfma_f32_16x16x32_bf16 v[204:207], v[236:239], v[156:159], v[204:207]
    v_mfma_f32_16x16x32_bf16 v[176:179], v[224:227], v[152:155], v[176:179]
    s_waitcnt vmcnt(3)
    v_add3_u32 v248, v166, v32, v33
    v_add3_u32 v249, v34, v35, v36
    v_mfma_f32_16x16x32_bf16 v[180:183], v[228:231], v[152:155], v[180:183]
    v_add3_u32 v248, v248, v37, v38
    v_add3_u32 v248, v248, v249, v39
    v_cmp_ne_u32 vcc, s61, v248
    s_cbranch_vccnz L_slow27
L_back27:
    v_mfma_f32_16x16x32_bf16 v[184:187], v[208:211], v[36:39], v[184:187]
    buffer_load_dwordx4 v[48:51], v25, s[24:27], s80 offen sc1
    buffer_load_dwordx4 v[52:55], v26, s[24:27], s80 offen sc1
    buffer_load_dword v168, v27, s[24:27], s80 offen sc1
    ds_read_b64_tr_b16 v[144:145], v21 offset:16384
    ds_read_b64_tr_b16 v[146:147], v21 offset:18432
    v_mfma_f32_16x16x32_bf16 v[188:191], v[212:215], v[36:39], v[188:191]
    ds_read_b64_tr_b16 v[148:149], v22 offset:16384
    ds_read_b64_tr_b16 v[150:151], v22 offset:18432
    ds_read_b64_tr_b16 v[152:153], v23 offset:16384
    ds_read_b64_tr_b16 v[154:155], v23 offset:18432
    v_mfma_f32_16x16x32_bf16 v[192:195], v[216:219], v[32:35], v[192:195]
    ds_read_b64_tr_b16 v[156:157], v24 offset:16384
    ds_read_b64_tr_b16 v[158:159], v24 offset:18432
    v_mfma_f32_16x16x32_bf16 v[196:199], v[220:223], v[32:35], v[196:199]
    v_mfma_f32_16x16x32_bf16 v[200:203], v[216:219], v[36:39], v[200:203]
    v_mfma_f32_16x16x32_bf16 v[204:207], v[220:223], v[36:39], v[204:207]
    v_mfma_f32_16x16x32_bf16 v[176:179], v[208:211], v[32:35], v[176:179]
    s_waitcnt vmcnt(3)
    v_add3_u32 v248, v167, v40, v41
    v_add3_u32 v249, v42, v43, v44
    v_mfma_f32_16x16x32_bf16 v[180:183], v[212:215], v[32:35], v[180:183]
    v_add3_u32 v248, v248, v45, v46
    v_add3_u32 v248, v248, v249, v47
    v_cmp_ne_u32 vcc, s61, v248
    s_cbranch_vccnz L_slow28
L_back28:
    v_mfma_f32_16x16x32_bf16 v[184:187], v[112:115], v[44:47], v[184:187]
    buffer_load_dwordx4 v[56:59], v25, s[24:27], s81 offen sc1
    buffer_load_dwordx4 v[60:63], v26, s[24:27], s81 offen sc1
    buffer_load_dword v169, v27, s[24:27], s81 offen sc1
    ds_read_b64_tr_b16 v[224:225], v21 offset:32768
    ds_read_b64_tr_b16 v[226:227], v21 offset:34816
    v_mfma_f32_16x16x32_bf16 v[188:191], v[116:119], v[44:47], v[188:191]
    ds_read_b64_tr_b16 v[228:229], v22 offset:32768
    ds_read_b64_tr_b16 v[230:231], v22 offset:34816
    ds_read_b64_tr_b16 v[232:233], v23 offset:32768
    ds_read_b64_tr_b16 v[234:235], v23 offset:34816
    v_mfma_f32_16x16x32_bf16 v[192:195], v[120:123], v[40:43], v[192:195]
    ds_read_b64_tr_b16 v[236:237], v24 offset:32768
    ds_read_b64_tr_b16 v[238:239], v24 offset:34816
    v_mfma_f32_16x16x32_bf16 v[196:199], v[124:127], v[40:43], v[196:199]
    v_mfma_f32_16x16x32_bf16 v[200:203], v[120:123], v[44:47], v[200:203]
    v_mfma_f32_16x16x32_bf16 v[204:207], v[124:127], v[44:47], v[204:207]
    v_mfma_f32_16x16x32_bf16 v[176:179], v[112:115], v[40:43], v[176:179]
    s_waitcnt vmcnt(3)
    v_add3_u32 v248, v168, v48, v49
    v_add3_u32 v249, v50, v51, v52
    v_mfma_f32_16x16x32_bf16 v[180:183], v[116:119], v[40:43], v[180:183]
    v_add3_u32 v248, v248, v53, v54
    v_add3_u32 v248, v248, v249, v55
    v_cmp_ne_u32 vcc, s61, v248
    s_cbranch_vccnz L_slow29
L_back29:
    s_waitcnt lgkmcnt(15)
    v_mfma_f32_16x16x32_bf16 v[184:187], v[128:131], v[52:55], v[184:187]
    buffer_load_dwordx4 v[64:67], v25, s[24:27], s82 offen sc1
    buffer_load_dwordx4 v[68:71], v26, s[24:27], s82 offen sc1
    buffer_load_dword v170, v27, s[24:27], s82 offen sc1
    ds_read_b64_tr_b16 v[208:209], v21 offset:49152
    ds_read_b64_tr_b16 v[210:211], v21 offset:51200
    v_mfma_f32_16x16x32_bf16 v[188:191], v[132:135], v[52:55], v[188:191]
    ds_read_b64_tr_b16 v[212:213], v22 offset:49152
    ds_read_b64_tr_b16 v[214:215], v22 offset:51200
    ds_read_b64_tr_b16 v[216:217], v23 offset:49152
    ds_read_b64_tr_b16 v[218:219], v23 offset:51200
    v_mfma_f32_16x16x32_bf16 v[192:195], v[136:139], v[48:51], v[192:195]
    ds_read_b64_tr_b16 v[220:221], v24 offset:49152
    ds_read_b64_tr_b16 v[222:223], v24 offset:51200
    v_mfma_f32_16x16x32_bf16 v[196:199], v[140:143], v[48:51], v[196:199]
    v_mfma_f32_16x16x32_bf16 v[200:203], v[136:139], v[52:55], v[200:203]
    v_mfma_f32_16x16x32_bf16 v[204:207], v[140:143], v[52:55], v[204:207]
    v_mfma_f32_16x16x32_bf16 v[176:179], v[128:131], v[48:51], v[176:179]
    s_waitcnt vmcnt(3)
    v_add3_u32 v248, v169, v56, v57
    v_add3_u32 v249, v58, v59, v60
    v_mfma_f32_16x16x32_bf16 v[180:183], v[132:135], v[48:51], v[180:183]
    v_add3_u32 v248, v248, v61, v62
    v_add3_u32 v248, v248, v249, v63
    v_cmp_ne_u32 vcc, s61, v248
    s_cbranch_vccnz L_slow30
L_back30:
    s_waitcnt lgkmcnt(15)
    v_mfma_f32_16x16x32_bf16 v[184:187], v[144:147], v[60:63], v[184:187]
    buffer_load_dwordx4 v[72:75], v25, s[24:27], s83 offen sc1
    buffer_load_dwordx4 v[76:79], v26, s[24:27], s83 offen sc1
    buffer_load_dword v171, v27, s[24:27], s83 offen sc1
    v_add_u32 v21, 0x20000, v21
    v_add_u32 v22, 0x20000, v22
    v_mfma_f32_16x16x32_bf16 v[188:191], v[148:151], v[60:63], v[188:191]
    v_add_u32 v23, 0x20000, v23
    v_add_u32 v24, 0x20000, v24
    ds_read_b64_tr_b16 v[112:113], v21 offset:0
    ds_read_b64_tr_b16 v[114:115], v21 offset:2048
    v_mfma_f32_16x16x32_bf16 v[192:195], v[152:155], v[56:59], v[192:195]
    ds_read_b64_tr_b16 v[116:117], v22 offset:0
    ds_read_b64_tr_b16 v[118:119], v22 offset:2048
    ds_read_b64_tr_b16 v[120:121], v23 offset:0
    ds_read_b64_tr_b16 v[122:123], v23 offset:2048
    ds_read_b64_tr_b16 v[124:125], v24 offset:0
    v_mfma_f32_16x16x32_bf16 v[196:199], v[156:159], v[56:59], v[196:199]
    ds_read_b64_tr_b16 v[126:127], v24 offset:2048
    v_add_u32 v248, v253, v255
    v_cmp_ne_u32 vcc, s62, v248
    s_cbranch_vccnz L_slow31
L_back31:
    v_mfma_f32_16x16x32_bf16 v[200:203], v[152:155], v[60:63], v[200:203]
    v_mfma_f32_16x16x32_bf16 v[204:207], v[156:159], v[60:63], v[204:207]
    v_mfma_f32_16x16x32_bf16 v[176:179], v[144:147], v[56:59], v[176:179]
    s_waitcnt vmcnt(3)
    v_add3_u32 v248, v170, v64, v65
    v_add3_u32 v249, v66, v67, v68
    v_mfma_f32_16x16x32_bf16 v[180:183], v[148:151], v[56:59], v[180:183]
    v_add3_u32 v248, v248, v69, v70
    v_add3_u32 v248, v248, v249, v71
    v_cmp_ne_u32 vcc, s23, v248
    s_cbranch_vccnz L_slow32
L_back32:
    s_waitcnt lgkmcnt(15)
    v_mfma_f32_16x16x32_bf16 v[184:187], v[224:227], v[68:71], v[184:187]
    v_sub_f32 v252, 1.0, v252
    v_sub_f32 v254, 1.0, v254
    buffer_load_dwordx4 v[80:83], v25, s[24:27], s84 offen sc1
    buffer_load_dwordx4 v[84:87], v26, s[24:27], s84 offen sc1
    buffer_load_dword v172, v27, s[24:27], s84 offen sc1
    ds_read_b64_tr_b16 v[128:129], v21 offset:16384
    ds_read_b64_tr_b16 v[130:131], v21 offset:18432
    ds_read_b64_tr_b16 v[132:133], v22 offset:16384
    v_mfma_f32_16x16x32_bf16 v[188:191], v[228:231], v[68:71], v[188:191]
    ds_read_b64_tr_b16 v[134:135], v22 offset:18432
    ds_read_b64_tr_b16 v[136:137], v23 offset:16384
    ds_read_b64_tr_b16 v[138:139], v23 offset:18432
    ds_read_b64_tr_b16 v[140:141], v24 offset:16384
    ds_read_b64_tr_b16 v[142:143], v24 offset:18432
    v_mfma_f32_16x16x32_bf16 v[192:195], v[232:235], v[64:67], v[192:195]
    v_mfma_f32_16x16x32_bf16 v[196:199], v[236:239], v[64:67], v[196:199]
    v_mfma_f32_16x16x32_bf16 v[200:203], v[232:235], v[68:71], v[200:203]
    v_mul_f32 v184, v254, v184
    v_mul_f32 v185, v254, v185
    v_mul_f32 v186, v254, v186
    v_mul_f32 v187, v254, v187
    s_waitcnt vmcnt(3)
    v_add3_u32 v248, v171, v72, v73
    v_add3_u32 v249, v74, v75, v76
    v_add3_u32 v248, v248, v77, v78
    v_add3_u32 v248, v248, v249, v79
    v_cmp_ne_u32 vcc, s61, v248
    s_cbranch_vccnz L_slow33
L_back33:
    v_mfma_f32_16x16x32_bf16 v[204:207], v[236:239], v[68:71], v[204:207]
    v_mul_f32 v188, v254, v188
    v_mul_f32 v189, v254, v189
    v_mul_f32 v190, v254, v190
    v_mul_f32 v191, v254, v191
    v_mfma_f32_16x16x32_bf16 v[176:179], v[224:227], v[64:67], v[176:179]
    v_mul_f32 v192, v252, v192
    v_mul_f32 v193, v252, v193
    v_mul_f32 v194, v252, v194
    v_mul_f32 v195, v252, v195
    v_mfma_f32_16x16x32_bf16 v[180:183], v[228:231], v[64:67], v[180:183]
    v_mul_f32 v196, v252, v196
    v_mul_f32 v197, v252, v197
    v_mul_f32 v198, v252, v198
    v_mul_f32 v199, v252, v199
    s_waitcnt lgkmcnt(15)
    v_mul_f32 v200, v254, v200
    v_mul_f32 v201, v254, v201
    v_mul_f32 v202, v254, v202
    v_mul_f32 v203, v254, v203
    v_mfma_f32_16x16x32_bf16 v[184:187], v[208:211], v[76:79], v[184:187]
    v_mul_f32 v204, v254, v204
    v_mul_f32 v205, v254, v205
    v_mul_f32 v206, v254, v206
    v_mul_f32 v207, v254, v207
    v_mfma_f32_16x16x32_bf16 v[188:191], v[212:215], v[76:79], v[188:191]
    v_mul_f32 v176, v252, v176
    v_mul_f32 v177, v252, v177
    v_mul_f32 v178, v252, v178
    v_mul_f32 v179, v252, v179
    v_mfma_f32_16x16x32_bf16 v[192:195], v[216:219], v[72:75], v[192:195]
    v_mul_f32 v180, v252, v180
    v_mul_f32 v181, v252, v181
    v_mul_f32 v182, v252, v182
    v_mul_f32 v183, v252, v183
    v_mfma_f32_16x16x32_bf16 v[196:199], v[220:223], v[72:75], v[196:199]
    buffer_load_dwordx4 v[88:91], v25, s[24:27], s85 offen sc1
    buffer_load_dwordx4 v[92:95], v26, s[24:27], s85 offen sc1
    buffer_load_dword v173, v27, s[24:27], s85 offen sc1
    v_add_u32 v21, 0xffff0000, v21
    v_add_u32 v22, 0xffff0000, v22
    v_add_u32 v23, 0xffff0000, v23
    v_add_u32 v24, 0xffff0000, v24
    ds_read_b64_tr_b16 v[144:145], v21 offset:0
    v_mfma_f32_16x16x32_bf16 v[200:203], v[216:219], v[76:79], v[200:203]
    ds_read_b64_tr_b16 v[146:147], v21 offset:2048
    ds_read_b64_tr_b16 v[148:149], v22 offset:0
    ds_read_b64_tr_b16 v[150:151], v22 offset:2048
    ds_read_b64_tr_b16 v[152:153], v23 offset:0
    ds_read_b64_tr_b16 v[154:155], v23 offset:2048
    ds_read_b64_tr_b16 v[156:157], v24 offset:0
    ds_read_b64_tr_b16 v[158:159], v24 offset:2048
    v_mfma_f32_16x16x32_bf16 v[204:207], v[220:223], v[76:79], v[204:207]
    s_waitcnt vmcnt(3)
    v_add3_u32 v248, v172, v80, v81
    v_add3_u32 v249, v82, v83, v84
    v_add3_u32 v248, v248, v85, v86
    v_add3_u32 v248, v248, v249, v87
    v_cmp_ne_u32 vcc, s61, v248
    s_cbranch_vccnz L_slow34
L_back34:
    s_waitcnt lgkmcnt(15)
    v_mfma_f32_16x16x32_bf16 v[184:187], v[112:115], v[84:87], v[184:187]
    buffer_load_dwordx4 v[96:99], v25, s[24:27], s86 offen sc1
    buffer_load_dwordx4 v[100:103], v26, s[24:27], s86 offen sc1
    buffer_load_dword v174, v27, s[24:27], s86 offen sc1
    s_xor_b32 s67, s48, 1
    s_xor_b32 s68, s48, 2
    v_mfma_f32_16x16x32_bf16 v[188:191], v[116:119], v[84:87], v[188:191]
    s_xor_b32 s69, s48, 3
    s_mul_i32 s66, s48, 6144
    s_mul_i32 s67, s67, 6144
    s_mul_i32 s68, s68, 6144
    v_mfma_f32_16x16x32_bf16 v[192:195], v[120:123], v[80:83], v[192:195]
    s_mul_i32 s69, s69, 6144
    v_add_u32 v10, 81920, v2
    v_add_u32 v6, s66, v10
    v_add_u32 v7, s67, v10
    v_add_u32 v8, s68, v10
    v_mfma_f32_16x16x32_bf16 v[196:199], v[124:127], v[80:83], v[196:199]
    v_add_u32 v9, s69, v10
    v_mfma_f32_16x16x32_bf16 v[200:203], v[120:123], v[84:87], v[200:203]
    v_mfma_f32_16x16x32_bf16 v[204:207], v[124:127], v[84:87], v[204:207]
    s_waitcnt vmcnt(3)
    v_add3_u32 v248, v173, v88, v89
    v_add3_u32 v249, v90, v91, v92
    v_add3_u32 v248, v248, v93, v94
    v_add3_u32 v248, v248, v249, v95
    v_cmp_ne_u32 vcc, s61, v248
    s_cbranch_vccnz L_slow35
L_back35:
    s_waitcnt lgkmcnt(8)
    v_mfma_f32_16x16x32_bf16 v[184:187], v[128:131], v[92:95], v[184:187]
    v_mfma_f32_16x16x32_bf16 v[188:191], v[132:135], v[92:95], v[188:191]
    v_mfma_f32_16x16x32_bf16 v[192:195], v[136:139], v[88:91], v[192:195]
    v_mfma_f32_16x16x32_bf16 v[196:199], v[140:143], v[88:91], v[196:199]
    v_mfma_f32_16x16x32_bf16 v[200:203], v[136:139], v[92:95], v[200:203]
    v_mfma_f32_16x16x32_bf16 v[204:207], v[140:143], v[92:95], v[204:207]
    s_waitcnt vmcnt(0)
    v_add3_u32 v248, v174, v96, v97
    v_add3_u32 v249, v98, v99, v100
    v_add3_u32 v248, v248, v101, v102
    v_add3_u32 v248, v248, v249, v103
    v_cmp_ne_u32 vcc, s61, v248
    s_cbranch_vccnz L_slow36
L_back36:
    s_waitcnt lgkmcnt(0)
    v_mfma_f32_16x16x32_bf16 v[184:187], v[144:147], v[100:103], v[184:187]
    v_mfma_f32_16x16x32_bf16 v[188:191], v[148:151], v[100:103], v[188:191]
    v_mfma_f32_16x16x32_bf16 v[192:195], v[152:155], v[96:99], v[192:195]
    v_mfma_f32_16x16x32_bf16 v[196:199], v[156:159], v[96:99], v[196:199]
    v_mfma_f32_16x16x32_bf16 v[200:203], v[152:155], v[100:103], v[200:203]
    v_mfma_f32_16x16x32_bf16 v[204:207], v[156:159], v[100:103], v[204:207]
    s_nop 2
    ds_write_b128 v7, v[184:187] offset:0
    ds_write_b128 v7, v[188:191] offset:1024
    v_mfma_f32_16x16x32_bf16 v[176:179], v[208:211], v[72:75], v[176:179]
    ds_write_b128 v8, v[192:195] offset:2048
    ds_write_b128 v8, v[196:199] offset:3072
    v_mfma_f32_16x16x32_bf16 v[180:183], v[212:215], v[72:75], v[180:183]
    ds_write_b128 v9, v[200:203] offset:4096
    ds_write_b128 v9, v[204:207] offset:5120
    v_mfma_f32_16x16x32_bf16 v[176:179], v[112:115], v[80:83], v[176:179]
    v_mfma_f32_16x16x32_bf16 v[180:183], v[116:119], v[80:83], v[180:183]
    v_mfma_f32_16x16x32_bf16 v[176:179], v[128:131], v[88:91], v[176:179]
    v_mfma_f32_16x16x32_bf16 v[180:183], v[132:135], v[88:91], v[180:183]
    v_mfma_f32_16x16x32_bf16 v[176:179], v[144:147], v[96:99], v[176:179]
    v_mfma_f32_16x16x32_bf16 v[180:183], v[148:151], v[96:99], v[180:183]
    s_waitcnt lgkmcnt(0)
    s_barrier
    ds_read_b128 v[32:35], v6 offset:0
    ds_read_b128 v[36:39], v6 offset:1024
    ds_read_b128 v[40:43], v6 offset:2048
    ds_read_b128 v[44:47], v6 offset:3072
    ds_read_b128 v[48:51], v6 offset:4096
    ds_read_b128 v[52:55], v6 offset:5120
    s_waitcnt lgkmcnt(3)
    v_pk_add_f32 v[32:33], v[32:33], v[40:41]
    v_pk_add_f32 v[34:35], v[34:35], v[42:43]
    s_waitcnt lgkmcnt(2)
    v_pk_add_f32 v[36:37], v[36:37], v[44:45]
    v_pk_add_f32 v[38:39], v[38:39], v[46:47]
    s_waitcnt lgkmcnt(1)
    v_pk_add_f32 v[32:33], v[32:33], v[48:49]
    v_pk_add_f32 v[34:35], v[34:35], v[50:51]
    s_waitcnt lgkmcnt(0)
    v_pk_add_f32 v[36:37], v[36:37], v[52:53]
    v_pk_add_f32 v[38:39], v[38:39], v[54:55]
    v_pk_add_f32 v[176:177], v[176:177], v[32:33]
    v_pk_add_f32 v[178:179], v[178:179], v[34:35]
    v_pk_add_f32 v[180:181], v[180:181], v[36:37]
    v_pk_add_f32 v[182:183], v[182:183], v[38:39]
    v_cvt_pk_bf16_f32 v240, v176, v177
    v_cvt_pk_bf16_f32 v241, v178, v179
    v_cvt_pk_bf16_f32 v242, v180, v181
    v_cvt_pk_bf16_f32 v243, v182, v183
    s_nop 0
    v_permlane16_swap_b32 v240, v242
    v_permlane16_swap_b32 v241, v243
    buffer_store_dwordx4 v[240:243], v3, s[40:43], s71 offen
    s_barrier
L_fin:
    s_nop 1
L_end:
    s_endpgm

L_slow1:
    s_sub_u32 s60, s60, 1
    s_cbranch_scc1 L_give1
    s_nop 7
    s_nop 3
    buffer_load_dword v247, off, s[28:31], 0 sc1
    s_waitcnt vmcnt(0)
    v_cmp_eq_u32 vcc, 0, v247
    s_cbranch_vccnz L_slow1
    s_branch L_back1
L_give1:
    s_mov_b32 s60, 0
    s_waitcnt vmcnt(0)
    s_branch L_back1
L_slow2:
    s_sub_u32 s60, s60, 1
    s_cbranch_scc1 L_give2
    s_nop 7
    s_nop 3
    buffer_load_dwordx2 v[4:5], v3, s[24:27], s93 offen offset:0 sc1
    buffer_load_dwordx2 v[6:7], v3, s[24:27], s93 offen offset:128 sc1
    s_waitcnt vmcnt(0)
    v_add_u32 v240, v5, v7
    v_cmp_ne_u32 vcc, s62, v240
    s_cbranch_vccnz L_slow2
    s_branch L_back2
L_give2:
    s_mov_b32 s60, 0
    s_waitcnt vmcnt(0)
    s_branch L_back2
L_slow3:
    s_sub_u32 s60, s60, 1
    s_cbranch_scc1 L_give3
    s_nop 7
    s_nop 3
    buffer_load_dwordx4 v[112:115], v25, s[24:27], s72 offen sc1
    buffer_load_dwordx4 v[116:119], v26, s[24:27], s72 offen sc1
    buffer_load_dword v160, v27, s[24:27], s72 offen sc1
    s_waitcnt vmcnt(0)
    v_add3_u32 v248, v160, v112, v113
    v_add3_u32 v249, v114, v115, v116
    v_add3_u32 v248, v248, v117, v118
    v_add3_u32 v248, v248, v249, v119
    v_cmp_ne_u32 vcc, s61, v248
    s_cbranch_vccnz L_slow3
    buffer_load_dwordx4 v[120:123], v25, s[24:27], s73 offen sc1
    buffer_load_dwordx4 v[124:127], v26, s[24:27], s73 offen sc1
    buffer_load_dword v161, v27, s[24:27], s73 offen sc1
    buffer_load_dwordx4 v[128:131], v25, s[24:27], s74 offen sc1
    buffer_load_dwordx4 v[132:135], v26, s[24:27], s74 offen sc1
    buffer_load_dword v162, v27, s[24:27], s74 offen sc1
    s_branch L_back3
L_give3:
    s_mov_b32 s60, 0
    s_waitcnt vmcnt(0)
    s_branch L_back3
L_slow4:
    s_sub_u32 s60, s60, 1
    s_cbranch_scc1 L_give4
    s_nop 7
    s_nop 3
    buffer_load_dwordx4 v[120:123], v25, s[24:27], s73 offen sc1
    buffer_load_dwordx4 v[124:127], v26, s[24:27], s73 offen sc1
    buffer_load_dword v161, v27, s[24:27], s73 offen sc1
    s_waitcnt vmcnt(0)
    v_add3_u32 v248, v161, v120, v121
    v_add3_u32 v249, v122, v123, v124
    v_add3_u32 v248, v248, v125, v126
    v_add3_u32 v248, v248, v249, v127
    v_cmp_ne_u32 vcc, s61, v248
    s_cbranch_vccnz L_slow4
    buffer_load_dwordx4 v[128:131], v25, s[24:27], s74 offen sc1
    buffer_load_dwordx4 v[132:135], v26, s[24:27], s74 offen sc1
    buffer_load_dword v162, v27, s[24:27], s74 offen sc1
    s_branch L_back4
L_give4:
    s_mov_b32 s60, 0
    s_waitcnt vmcnt(0)
    s_branch L_back4
L_slow5:
    s_sub_u32 s60, s60, 1
    s_cbranch_scc1 L_give5
    s_nop 7
    s_nop 3
    buffer_load_dwordx4 v[128:131], v25, s[24:27], s74 offen sc1
    buffer_load_dwordx4 v[132:135], v26, s[24:27], s74 offen sc1
    buffer_load_dword v162, v27, s[24:27], s74 offen sc1
    s_waitcnt vmcnt(0)
    v_add3_u32 v248, v162, v128, v129
    v_add3_u32 v249, v130, v131, v132
    v_add3_u32 v248, v248, v133, v134
    v_add3_u32 v248, v248, v249, v135
    v_cmp_ne_u32 vcc, s61, v248
    s_cbranch_vccnz L_slow5
    buffer_load_dwordx4 v[136:139], v25, s[24:27], s75 offen sc1
    buffer_load_dwordx4 v[140:143], v26, s[24:27], s75 offen sc1
    buffer_load_dword v163, v27, s[24:27], s75 offen sc1
    s_branch L_back5
L_give5:
    s_mov_b32 s60, 0
    s_waitcnt vmcnt(0)
    s_branch L_back5
L_slow6:
    s_sub_u32 s60, s60, 1
    s_cbranch_scc1 L_give6
    s_nop 7
    s_nop 3
    buffer_load_dwordx4 v[136:139], v25, s[24:27], s75 offen sc1
    buffer_load_dwordx4 v[140:143], v26, s[24:27], s75 offen sc1
    buffer_load_dword v163, v27, s[24:27], s75 offen sc1
    s_waitcnt vmcnt(0)
    v_add3_u32 v248, v163, v136, v137
    v_add3_u32 v249, v138, v139, v140
    v_add3_u32 v248, v248, v141, v142
    v_add3_u32 v248, v248, v249, v143
    v_cmp_ne_u32 vcc, s61, v248
    s_cbranch_vccnz L_slow6
    buffer_load_dwordx4 v[144:147], v25, s[24:27], s76 offen sc1
    buffer_load_dwordx4 v[148:151], v26, s[24:27], s76 offen sc1
    buffer_load_dword v164, v27, s[24:27], s76 offen sc1
    s_branch L_back6
L_give6:
    s_mov_b32 s60, 0
    s_waitcnt vmcnt(0)
    s_branch L_back6
L_slow7:
    s_sub_u32 s60, s60, 1
    s_cbranch_scc1 L_give7
    s_nop 7
    s_nop 3
    buffer_load_dwordx4 v[144:147], v25, s[24:27], s76 offen sc1
    buffer_load_dwordx4 v[148:151], v26, s[24:27], s76 offen sc1
    buffer_load_dword v164, v27, s[24:27], s76 offen sc1
    s_waitcnt vmcnt(0)
    v_add3_u32 v248, v164, v144, v145
    v_add3_u32 v249, v146, v147, v148
    v_add3_u32 v248, v248, v149, v150
    v_add3_u32 v248, v248, v249, v151
    v_cmp_ne_u32 vcc, s61, v248
    s_cbranch_vccnz L_slow7
    buffer_load_dwordx4 v[152:155], v25, s[24:27], s77 offen sc1
    buffer_load_dwordx4 v[156:159], v26, s[24:27], s77 offen sc1
    buffer_load_dword v165, v27, s[24:27], s77 offen sc1
    buffer_load_dwordx2 v[252:253], v4, s[24:27], s93 offen sc1
    buffer_load_dwordx2 v[254:255], v5, s[24:27], s93 offen sc1
    s_branch L_back7
L_give7:
    s_mov_b32 s60, 0
    s_waitcnt vmcnt(0)
    s_branch L_back7
L_slow8:
    s_sub_u32 s60, s60, 1
    s_cbranch_scc1 L_give8
    s_nop 7
    s_nop 3
    buffer_load_dwordx4 v[152:155], v25, s[24:27], s77 offen sc1
    buffer_load_dwordx4 v[156:159], v26, s[24:27], s77 offen sc1
    buffer_load_dword v165, v27, s[24:27], s77 offen sc1
    s_waitcnt vmcnt(0)
    v_add3_u32 v248, v165, v152, v153
    v_add3_u32 v249, v154, v155, v156
    v_add3_u32 v248, v248, v157, v158
    v_add3_u32 v248, v248, v249, v159
    v_cmp_ne_u32 vcc, s61, v248
    s_cbranch_vccnz L_slow8
    buffer_load_dwordx2 v[252:253], v4, s[24:27], s93 offen sc1
    buffer_load_dwordx2 v[254:255], v5, s[24:27], s93 offen sc1
    buffer_load_dwordx4 v[32:35], v25, s[24:27], s78 offen sc1
    buffer_load_dwordx4 v[36:39], v26, s[24:27], s78 offen sc1
    buffer_load_dword v166, v27, s[24:27], s78 offen sc1
    s_branch L_back8
L_give8:
    s_mov_b32 s60, 0
    s_waitcnt vmcnt(0)
    s_branch L_back8
L_slow9:
    s_sub_u32 s60, s60, 1
    s_cbranch_scc1 L_give9
    s_nop 7
    s_nop 3
    buffer_load_dwordx4 v[32:35], v25, s[24:27], s78 offen sc1
    buffer_load_dwordx4 v[36:39], v26, s[24:27], s78 offen sc1
    buffer_load_dword v166, v27, s[24:27], s78 offen sc1
    s_waitcnt vmcnt(0)
    v_add3_u32 v248, v166, v32, v33
    v_add3_u32 v249, v34, v35, v36
    v_add3_u32 v248, v248, v37, v38
    v_add3_u32 v248, v248, v249, v39
    v_cmp_ne_u32 vcc, s61, v248
    s_cbranch_vccnz L_slow9
    buffer_load_dwordx4 v[40:43], v25, s[24:27], s79 offen sc1
    buffer_load_dwordx4 v[44:47], v26, s[24:27], s79 offen sc1
    buffer_load_dword v167, v27, s[24:27], s79 offen sc1
    s_branch L_back9
L_give9:
    s_mov_b32 s60, 0
    s_waitcnt vmcnt(0)
    s_branch L_back9
L_slow10:
    s_sub_u32 s60, s60, 1
    s_cbranch_scc1 L_give10
    s_nop 7
    s_nop 3
    buffer_load_dwordx4 v[40:43], v25, s[24:27], s79 offen sc1
    buffer_load_dwordx4 v[44:47], v26, s[24:27], s79 offen sc1
    buffer_load_dword v167, v27, s[24:27], s79 offen sc1
    s_waitcnt vmcnt(0)
    v_add3_u32 v248, v167, v40, v41
    v_add3_u32 v249, v42, v43, v44
    v_add3_u32 v248, v248, v45, v46
    v_add3_u32 v248, v248, v249, v47
    v_cmp_ne_u32 vcc, s61, v248
    s_cbranch_vccnz L_slow10
    buffer_load_dwordx4 v[48:51], v25, s[24:27], s80 offen sc1
    buffer_load_dwordx4 v[52:55], v26, s[24:27], s80 offen sc1
    buffer_load_dword v168, v27, s[24:27], s80 offen sc1
    s_branch L_back10
L_give10:
    s_mov_b32 s60, 0
    s_waitcnt vmcnt(0)
    s_branch L_back10
L_slow11:
    s_sub_u32 s60, s60, 1
    s_cbranch_scc1 L_give11
    s_nop 7
    s_nop 3
    buffer_load_dwordx4 v[48:51], v25, s[24:27], s80 offen sc1
    buffer_load_dwordx4 v[52:55], v26, s[24:27], s80 offen sc1
    buffer_load_dword v168, v27, s[24:27], s80 offen sc1
    s_waitcnt vmcnt(0)
    v_add3_u32 v248, v168, v48, v49
    v_add3_u32 v249, v50, v51, v52
    v_add3_u32 v248, v248, v53, v54
    v_add3_u32 v248, v248, v249, v55
    v_cmp_ne_u32 vcc, s61, v248
    s_cbranch_vccnz L_slow11
    buffer_load_dwordx4 v[56:59], v25, s[24:27], s81 offen sc1
    buffer_load_dwordx4 v[60:63], v26, s[24:27], s81 offen sc1
    buffer_load_dword v169, v27, s[24:27], s81 offen sc1
    s_branch L_back11
L_give11:
    s_mov_b32 s60, 0
    s_waitcnt vmcnt(0)
    s_branch L_back11
L_slow12:
    s_sub_u32 s60, s60, 1
    s_cbranch_scc1 L_give12
    s_nop 7
    s_nop 3
    buffer_load_dwordx4 v[56:59], v25, s[24:27], s81 offen sc1
    buffer_load_dwordx4 v[60:63], v26, s[24:27], s81 offen sc1
    buffer_load_dword v169, v27, s[24:27], s81 offen sc1
    s_waitcnt vmcnt(0)
    v_add3_u32 v248, v169, v56, v57
    v_add3_u32 v249, v58, v59, v60
    v_add3_u32 v248, v248, v61, v62
    v_add3_u32 v248, v248, v249, v63
    v_cmp_ne_u32 vcc, s61, v248
    s_cbranch_vccnz L_slow12
    buffer_load_dwordx4 v[64:67], v25, s[24:27], s82 offen sc1
    buffer_load_dwordx4 v[68:71], v26, s[24:27], s82 offen sc1
    buffer_load_dword v170, v27, s[24:27], s82 offen sc1
    s_branch L_back12
L_give12:
    s_mov_b32 s60, 0
    s_waitcnt vmcnt(0)
    s_branch L_back12
L_slow13:
    s_sub_u32 s60, s60, 1
    s_cbranch_scc1 L_give13
    s_nop 7
    s_nop 3
    buffer_load_dwordx2 v[252:253], v4, s[24:27], s93 offen sc1
    buffer_load_dwordx2 v[254:255], v5, s[24:27], s93 offen sc1
    s_waitcnt vmcnt(0)
    v_add_u32 v248, v253, v255
    v_cmp_ne_u32 vcc, s62, v248
    s_cbranch_vccnz L_slow13
    buffer_load_dwordx4 v[64:67], v25, s[24:27], s82 offen sc1
    buffer_load_dwordx4 v[68:71], v26, s[24:27], s82 offen sc1
    buffer_load_dword v170, v27, s[24:27], s82 offen sc1
    buffer_load_dwordx4 v[72:75], v25, s[24:27], s83 offen sc1
    buffer_load_dwordx4 v[76:79], v26, s[24:27], s83 offen sc1
    buffer_load_dword v171, v27, s[24:27], s83 offen sc1
    s_branch L_back13
L_give13:
    s_mov_b32 s60, 0
    s_waitcnt vmcnt(0)
    s_branch L_back13
L_slow14:
    s_sub_u32 s60, s60, 1
    s_cbranch_scc1 L_give14
    s_nop 7
    s_nop 3
    buffer_load_dwordx4 v[64:67], v25, s[24:27], s82 offen sc1
    buffer_load_dwordx4 v[68:71], v26, s[24:27], s82 offen sc1
    buffer_load_dword v170, v27, s[24:27], s82 offen sc1
    s_waitcnt vmcnt(0)
    v_add3_u32 v248, v170, v64, v65
    v_add3_u32 v249, v66, v67, v68
    v_add3_u32 v248, v248, v69, v70
    v_add3_u32 v248, v248, v249, v71
    v_cmp_ne_u32 vcc, s23, v248
    s_cbranch_vccnz L_slow14
    buffer_load_dwordx4 v[72:75], v25, s[24:27], s83 offen sc1
    buffer_load_dwordx4 v[76:79], v26, s[24:27], s83 offen sc1
    buffer_load_dword v171, v27, s[24:27], s83 offen sc1
    s_branch L_back14
L_give14:
    s_mov_b32 s60, 0
    s_waitcnt vmcnt(0)
    s_branch L_back14
L_slow15:
    s_sub_u32 s60, s60, 1
    s_cbranch_scc1 L_give15
    s_nop 7
    s_nop 3
    buffer_load_dwordx4 v[72:75], v25, s[24:27], s83 offen sc1
    buffer_load_dwordx4 v[76:79], v26, s[24:27], s83 offen sc1
    buffer_load_dword v171, v27, s[24:27], s83 offen sc1
    s_waitcnt vmcnt(0)
    v_add3_u32 v248, v171, v72, v73
    v_add3_u32 v249, v74, v75, v76
    v_add3_u32 v248, v248, v77, v78
    v_add3_u32 v248, v248, v249, v79
    v_cmp_ne_u32 vcc, s61, v248
    s_cbranch_vccnz L_slow15
    buffer_load_dwordx4 v[80:83], v25, s[24:27], s84 offen sc1
    buffer_load_dwordx4 v[84:87], v26, s[24:27], s84 offen sc1
    buffer_load_dword v172, v27, s[24:27], s84 offen sc1
    s_branch L_back15
L_give15:
    s_mov_b32 s60, 0
    s_waitcnt vmcnt(0)
    s_branch L_back15
L_slow16:
    s_sub_u32 s60, s60, 1
    s_cbranch_scc1 L_give16
    s_nop 7
    s_nop 3
    buffer_load_dwordx4 v[80:83], v25, s[24:27], s84 offen sc1
    buffer_load_dwordx4 v[84:87], v26, s[24:27], s84 offen sc1
    buffer_load_dword v172, v27, s[24:27], s84 offen sc1
    s_waitcnt vmcnt(0)
    v_add3_u32 v248, v172, v80, v81
    v_add3_u32 v249, v82, v83, v84
    v_add3_u32 v248, v248, v85, v86
    v_add3_u32 v248, v248, v249, v87
    v_cmp_ne_u32 vcc, s61, v248
    s_cbranch_vccnz L_slow16
    buffer_load_dwordx4 v[88:91], v25, s[24:27], s85 offen sc1
    buffer_load_dwordx4 v[92:95], v26, s[24:27], s85 offen sc1
    buffer_load_dword v173, v27, s[24:27], s85 offen sc1
    s_branch L_back16
L_give16:
    s_mov_b32 s60, 0
    s_waitcnt vmcnt(0)
    s_branch L_back16
L_slow17:
    s_sub_u32 s60, s60, 1
    s_cbranch_scc1 L_give17
    s_nop 7
    s_nop 3
    buffer_load_dwordx4 v[88:91], v25, s[24:27], s85 offen sc1
    buffer_load_dwordx4 v[92:95], v26, s[24:27], s85 offen sc1
    buffer_load_dword v173, v27, s[24:27], s85 offen sc1
    s_waitcnt vmcnt(0)
    v_add3_u32 v248, v173, v88, v89
    v_add3_u32 v249, v90, v91, v92
    v_add3_u32 v248, v248, v93, v94
    v_add3_u32 v248, v248, v249, v95
    v_cmp_ne_u32 vcc, s61, v248
    s_cbranch_vccnz L_slow17
    buffer_load_dwordx4 v[96:99], v25, s[24:27], s86 offen sc1
    buffer_load_dwordx4 v[100:103], v26, s[24:27], s86 offen sc1
    buffer_load_dword v174, v27, s[24:27], s86 offen sc1
    s_branch L_back17
L_give17:
    s_mov_b32 s60, 0
    s_waitcnt vmcnt(0)
    s_branch L_back17
L_slow18:
    s_sub_u32 s60, s60, 1
    s_cbranch_scc1 L_give18
    s_nop 7
    s_nop 3
    buffer_load_dwordx4 v[96:99], v25, s[24:27], s86 offen sc1
    buffer_load_dwordx4 v[100:103], v26, s[24:27], s86 offen sc1
    buffer_load_dword v174, v27, s[24:27], s86 offen sc1
    s_waitcnt vmcnt(0)
    v_add3_u32 v248, v174, v96, v97
    v_add3_u32 v249, v98, v99, v100
    v_add3_u32 v248, v248, v101, v102
    v_add3_u32 v248, v248, v249, v103
    v_cmp_ne_u32 vcc, s61, v248
    s_cbranch_vccnz L_slow18
    s_branch L_back18
L_give18:
    s_mov_b32 s60, 0
    s_waitcnt vmcnt(0)
    s_branch L_back18
L_slow19:
    s_sub_u32 s60, s60, 1
    s_cbranch_scc1 L_give19
    s_nop 7
    s_nop 3
    buffer_load_dword v4, off, s[28:31], 0 sc1
    s_waitcnt vmcnt(0)
    v_cmp_eq_u32 vcc, 0, v4
    s_cbranch_vccnz L_slow19
    s_branch L_back19
L_give19:
    s_mov_b32 s60, 0
    s_waitcnt vmcnt(0)
    s_branch L_back19
L_kvs:
    s_sub_u32 s60, s60, 1
    s_cbranch_scc1 L_kvg
    s_nop 7
    s_nop 3
    buffer_load_dwordx3 v[228:230], v12, s[24:27], s88 offen sc1
    buffer_load_dwordx4 v[176:179], v2, s[24:27], s87 offen offset:0 sc1
    buffer_load_dwordx4 v[180:183], v2, s[24:27], s87 offen offset:1024 sc1
    buffer_load_dwordx4 v[184:187], v2, s[24:27], s87 offen offset:2048 sc1
    buffer_load_dwordx4 v[188:191], v2, s[24:27], s87 offen offset:3072 sc1
    buffer_load_dwordx4 v[192:195], v2, s[24:27], s89 offen offset:0 sc1
    buffer_load_dwordx4 v[196:199], v2, s[24:27], s89 offen offset:1024 sc1
    buffer_load_dwordx4 v[200:203], v2, s[24:27], s89 offen offset:2048 sc1
    buffer_load_dwordx4 v[204:207], v2, s[24:27], s89 offen offset:3072 sc1
    s_waitcnt vmcnt(0) lgkmcnt(0)
    s_branch L_kvc
L_kvg:
    s_mov_b32 s60, 0
    s_branch L_kvd
L_slow20:
    s_sub_u32 s60, s60, 1
    s_cbranch_scc1 L_give20
    s_nop 7
    s_nop 3
    buffer_load_dword v4, off, s[28:31], 0 sc1
    s_waitcnt vmcnt(0)
    v_cmp_eq_u32 vcc, 0, v4
    s_cbranch_vccnz L_slow20
    s_branch L_back20
L_give20:
    s_mov_b32 s60, 0
    s_waitcnt vmcnt(0)
    s_branch L_back20
L_slow21:
    s_sub_u32 s60, s60, 1
    s_cbranch_scc1 L_give21
    s_nop 7
    s_nop 3
    buffer_load_dwordx4 v[112:115], v25, s[24:27], s72 offen sc1
    buffer_load_dwordx4 v[116:119], v26, s[24:27], s72 offen sc1
    buffer_load_dword v160, v27, s[24:27], s72 offen sc1
    s_waitcnt vmcnt(0)
    v_add3_u32 v248, v160, v112, v113
    v_add3_u32 v249, v114, v115, v116
    v_add3_u32 v248, v248, v117, v118
    v_add3_u32 v248, v248, v249, v119
    v_cmp_ne_u32 vcc, s61, v248
    s_cbranch_vccnz L_slow21
    buffer_load_dwordx4 v[120:123], v25, s[24:27], s73 offen sc1
    buffer_load_dwordx4 v[124:127], v26, s[24:27], s73 offen sc1
    buffer_load_dword v161, v27, s[24:27], s73 offen sc1
    buffer_load_dwordx4 v[128:131], v25, s[24:27], s74 offen sc1
    buffer_load_dwordx4 v[132:135], v26, s[24:27], s74 offen sc1
    buffer_load_dword v162, v27, s[24:27], s74 offen sc1
    buffer_load_dword v0, off, s[28:31], 0 offset:4080
    buffer_load_dword v0, off, s[28:31], 0 offset:4080
    buffer_load_dword v0, off, s[28:31], 0 offset:4080
    buffer_load_dword v0, off, s[28:31], 0 offset:4080
    s_branch L_back21
L_give21:
    s_mov_b32 s60, 0
    s_waitcnt vmcnt(0)
    s_branch L_back21
L_slow22:
    s_sub_u32 s60, s60, 1
    s_cbranch_scc1 L_give22
    s_nop 7
    s_nop 3
    buffer_load_dwordx4 v[120:123], v25, s[24:27], s73 offen sc1
    buffer_load_dwordx4 v[124:127], v26, s[24:27], s73 offen sc1
    buffer_load_dword v161, v27, s[24:27], s73 offen sc1
    s_waitcnt vmcnt(0)
    v_add3_u32 v248, v161, v120, v121
    v_add3_u32 v249, v122, v123, v124
    v_add3_u32 v248, v248, v125, v126
    v_add3_u32 v248, v248, v249, v127
    v_cmp_ne_u32 vcc, s61, v248
    s_cbranch_vccnz L_slow22
    buffer_load_dwordx4 v[128:131], v25, s[24:27], s74 offen sc1
    buffer_load_dwordx4 v[132:135], v26, s[24:27], s74 offen sc1
    buffer_load_dword v162, v27, s[24:27], s74 offen sc1
    buffer_load_dword v0, off, s[28:31], 0 offset:4080
    buffer_load_dword v0, off, s[28:31], 0 offset:4080
    buffer_load_dword v0, off, s[28:31], 0 offset:4080
    buffer_load_dword v0, off, s[28:31], 0 offset:4080
    s_branch L_back22
L_give22:
    s_mov_b32 s60, 0
    s_waitcnt vmcnt(0)
    s_branch L_back22
L_slow23:
    s_sub_u32 s60, s60, 1
    s_cbranch_scc1 L_give23
    s_nop 7
    s_nop 3
    buffer_load_dwordx4 v[128:131], v25, s[24:27], s74 offen sc1
    buffer_load_dwordx4 v[132:135], v26, s[24:27], s74 offen sc1
    buffer_load_dword v162, v27, s[24:27], s74 offen sc1
    s_waitcnt vmcnt(0)
    v_add3_u32 v248, v162, v128, v129
    v_add3_u32 v249, v130, v131, v132
    v_add3_u32 v248, v248, v133, v134
    v_add3_u32 v248, v248, v249, v135
    v_cmp_ne_u32 vcc, s61, v248
    s_cbranch_vccnz L_slow23
    buffer_load_dwordx4 v[136:139], v25, s[24:27], s75 offen sc1
    buffer_load_dwordx4 v[140:143], v26, s[24:27], s75 offen sc1
    buffer_load_dword v163, v27, s[24:27], s75 offen sc1
    buffer_load_dword v0, off, s[28:31], 0 offset:4080
    buffer_load_dword v0, off, s[28:31], 0 offset:4080
    buffer_load_dword v0, off, s[28:31], 0 offset:4080
    buffer_load_dword v0, off, s[28:31], 0 offset:4080
    s_branch L_back23
L_give23:
    s_mov_b32 s60, 0
    s_waitcnt vmcnt(0)
    s_branch L_back23
L_slow24:
    s_sub_u32 s60, s60, 1
    s_cbranch_scc1 L_give24
    s_nop 7
    s_nop 3
    buffer_load_dwordx4 v[136:139], v25, s[24:27], s75 offen sc1
    buffer_load_dwordx4 v[140:143], v26, s[24:27], s75 offen sc1
    buffer_load_dword v163, v27, s[24:27], s75 offen sc1
    s_waitcnt vmcnt(0)
    v_add3_u32 v248, v163, v136, v137
    v_add3_u32 v249, v138, v139, v140
    v_add3_u32 v248, v248, v141, v142
    v_add3_u32 v248, v248, v249, v143
    v_cmp_ne_u32 vcc, s61, v248
    s_cbranch_vccnz L_slow24
    buffer_load_dwordx4 v[144:147], v25, s[24:27], s76 offen sc1
    buffer_load_dwordx4 v[148:151], v26, s[24:27], s76 offen sc1
    buffer_load_dword v164, v27, s[24:27], s76 offen sc1
    s_branch L_back24
L_give24:
    s_mov_b32 s60, 0
    s_waitcnt vmcnt(0)
    s_branch L_back24
L_slow25:
    s_sub_u32 s60, s60, 1
    s_cbranch_scc1 L_give25
    s_nop 7
    s_nop 3
    buffer_load_dwordx4 v[144:147], v25, s[24:27], s76 offen sc1
    buffer_load_dwordx4 v[148:151], v26, s[24:27], s76 offen sc1
    buffer_load_dword v164, v27, s[24:27], s76 offen sc1
    s_waitcnt vmcnt(0)
    v_add3_u32 v248, v164, v144, v145
    v_add3_u32 v249, v146, v147, v148
    v_add3_u32 v248, v248, v149, v150
    v_add3_u32 v248, v248, v249, v151
    v_cmp_ne_u32 vcc, s61, v248
    s_cbranch_vccnz L_slow25
    buffer_load_dwordx4 v[152:155], v25, s[24:27], s77 offen sc1
    buffer_load_dwordx4 v[156:159], v26, s[24:27], s77 offen sc1
    buffer_load_dword v165, v27, s[24:27], s77 offen sc1
    buffer_load_dwordx2 v[252:253], v4, s[24:27], s93 offen sc1
    buffer_load_dwordx2 v[254:255], v5, s[24:27], s93 offen sc1
    s_branch L_back25
L_give25:
    s_mov_b32 s60, 0
    s_waitcnt vmcnt(0)
    s_branch L_back25
L_slow26:
    s_sub_u32 s60, s60, 1
    s_cbranch_scc1 L_give26
    s_nop 7
    s_nop 3
    buffer_load_dwordx4 v[152:155], v25, s[24:27], s77 offen sc1
    buffer_load_dwordx4 v[156:159], v26, s[24:27], s77 offen sc1
    buffer_load_dword v165, v27, s[24:27], s77 offen sc1
    s_waitcnt vmcnt(0)
    v_add3_u32 v248, v165, v152, v153
    v_add3_u32 v249, v154, v155, v156
    v_add3_u32 v248, v248, v157, v158
    v_add3_u32 v248, v248, v249, v159
    v_cmp_ne_u32 vcc, s61, v248
    s_cbranch_vccnz L_slow26
    buffer_load_dwordx2 v[252:253], v4, s[24:27], s93 offen sc1
    buffer_load_dwordx2 v[254:255], v5, s[24:27], s93 offen sc1
    buffer_load_dwordx4 v[32:35], v25, s[24:27], s78 offen sc1
    buffer_load_dwordx4 v[36:39], v26, s[24:27], s78 offen sc1
    buffer_load_dword v166, v27, s[24:27], s78 offen sc1
    s_branch L_back26
L_give26:
    s_mov_b32 s60, 0
    s_waitcnt vmcnt(0)
    s_branch L_back26
L_slow27:
    s_sub_u32 s60, s60, 1
    s_cbranch_scc1 L_give27
    s_nop 7
    s_nop 3
    buffer_load_dwordx4 v[32:35], v25, s[24:27], s78 offen sc1
    buffer_load_dwordx4 v[36:39], v26, s[24:27], s78 offen sc1
    buffer_load_dword v166, v27, s[24:27], s78 offen sc1
    s_waitcnt vmcnt(0)
    v_add3_u32 v248, v166, v32, v33
    v_add3_u32 v249, v34, v35, v36
    v_add3_u32 v248, v248, v37, v38
    v_add3_u32 v248, v248, v249, v39
    v_cmp_ne_u32 vcc, s61, v248
    s_cbranch_vccnz L_slow27
    buffer_load_dwordx4 v[40:43], v25, s[24:27], s79 offen sc1
    buffer_load_dwordx4 v[44:47], v26, s[24:27], s79 offen sc1
    buffer_load_dword v167, v27, s[24:27], s79 offen sc1
    s_branch L_back27
L_give27:
    s_mov_b32 s60, 0
    s_waitcnt vmcnt(0)
    s_branch L_back27
L_slow28:
    s_sub_u32 s60, s60, 1
    s_cbranch_scc1 L_give28
    s_nop 7
    s_nop 3
    buffer_load_dwordx4 v[40:43], v25, s[24:27], s79 offen sc1
    buffer_load_dwordx4 v[44:47], v26, s[24:27], s79 offen sc1
    buffer_load_dword v167, v27, s[24:27], s79 offen sc1
    s_waitcnt vmcnt(0)
    v_add3_u32 v248, v167, v40, v41
    v_add3_u32 v249, v42, v43, v44
    v_add3_u32 v248, v248, v45, v46
    v_add3_u32 v248, v248, v249, v47
    v_cmp_ne_u32 vcc, s61, v248
    s_cbranch_vccnz L_slow28
    buffer_load_dwordx4 v[48:51], v25, s[24:27], s80 offen sc1
    buffer_load_dwordx4 v[52:55], v26, s[24:27], s80 offen sc1
    buffer_load_dword v168, v27, s[24:27], s80 offen sc1
    s_branch L_back28
L_give28:
    s_mov_b32 s60, 0
    s_waitcnt vmcnt(0)
    s_branch L_back28
L_slow29:
    s_sub_u32 s60, s60, 1
    s_cbranch_scc1 L_give29
    s_nop 7
    s_nop 3
    buffer_load_dwordx4 v[48:51], v25, s[24:27], s80 offen sc1
    buffer_load_dwordx4 v[52:55], v26, s[24:27], s80 offen sc1
    buffer_load_dword v168, v27, s[24:27], s80 offen sc1
    s_waitcnt vmcnt(0)
    v_add3_u32 v248, v168, v48, v49
    v_add3_u32 v249, v50, v51, v52
    v_add3_u32 v248, v248, v53, v54
    v_add3_u32 v248, v248, v249, v55
    v_cmp_ne_u32 vcc, s61, v248
    s_cbranch_vccnz L_slow29
    buffer_load_dwordx4 v[56:59], v25, s[24:27], s81 offen sc1
    buffer_load_dwordx4 v[60:63], v26, s[24:27], s81 offen sc1
    buffer_load_dword v169, v27, s[24:27], s81 offen sc1
    s_branch L_back29
L_give29:
    s_mov_b32 s60, 0
    s_waitcnt vmcnt(0)
    s_branch L_back29
L_slow30:
    s_sub_u32 s60, s60, 1
    s_cbranch_scc1 L_give30
    s_nop 7
    s_nop 3
    buffer_load_dwordx4 v[56:59], v25, s[24:27], s81 offen sc1
    buffer_load_dwordx4 v[60:63], v26, s[24:27], s81 offen sc1
    buffer_load_dword v169, v27, s[24:27], s81 offen sc1
    s_waitcnt vmcnt(0)
    v_add3_u32 v248, v169, v56, v57
    v_add3_u32 v249, v58, v59, v60
    v_add3_u32 v248, v248, v61, v62
    v_add3_u32 v248, v248, v249, v63
    v_cmp_ne_u32 vcc, s61, v248
    s_cbranch_vccnz L_slow30
    buffer_load_dwordx4 v[64:67], v25, s[24:27], s82 offen sc1
    buffer_load_dwordx4 v[68:71], v26, s[24:27], s82 offen sc1
    buffer_load_dword v170, v27, s[24:27], s82 offen sc1
    s_branch L_back30
L_give30:
    s_mov_b32 s60, 0
    s_waitcnt vmcnt(0)
    s_branch L_back30
L_slow31:
    s_sub_u32 s60, s60, 1
    s_cbranch_scc1 L_give31
    s_nop 7
    s_nop 3
    buffer_load_dwordx2 v[252:253], v4, s[24:27], s93 offen sc1
    buffer_load_dwordx2 v[254:255], v5, s[24:27], s93 offen sc1
    s_waitcnt vmcnt(0)
    v_add_u32 v248, v253, v255
    v_cmp_ne_u32 vcc, s62, v248
    s_cbranch_vccnz L_slow31
    buffer_load_dwordx4 v[64:67], v25, s[24:27], s82 offen sc1
    buffer_load_dwordx4 v[68:71], v26, s[24:27], s82 offen sc1
    buffer_load_dword v170, v27, s[24:27], s82 offen sc1
    buffer_load_dwordx4 v[72:75], v25, s[24:27], s83 offen sc1
    buffer_load_dwordx4 v[76:79], v26, s[24:27], s83 offen sc1
    buffer_load_dword v171, v27, s[24:27], s83 offen sc1
    s_branch L_back31
L_give31:
    s_mov_b32 s60, 0
    s_waitcnt vmcnt(0)
    s_branch L_back31
L_slow32:
    s_sub_u32 s60, s60, 1
    s_cbranch_scc1 L_give32
    s_nop 7
    s_nop 3
    buffer_load_dwordx4 v[64:67], v25, s[24:27], s82 offen sc1
    buffer_load_dwordx4 v[68:71], v26, s[24:27], s82 offen sc1
    buffer_load_dword v170, v27, s[24:27], s82 offen sc1
    s_waitcnt vmcnt(0)
    v_add3_u32 v248, v170, v64, v65
    v_add3_u32 v249, v66, v67, v68
    v_add3_u32 v248, v248, v69, v70
    v_add3_u32 v248, v248, v249, v71
    v_cmp_ne_u32 vcc, s23, v248
    s_cbranch_vccnz L_slow32
    buffer_load_dwordx4 v[72:75], v25, s[24:27], s83 offen sc1
    buffer_load_dwordx4 v[76:79], v26, s[24:27], s83 offen sc1
    buffer_load_dword v171, v27, s[24:27], s83 offen sc1
    s_branch L_back32
L_give32:
    s_mov_b32 s60, 0
    s_waitcnt vmcnt(0)
    s_branch L_back32
L_slow33:
    s_sub_u32 s60, s60, 1
    s_cbranch_scc1 L_give33
    s_nop 7
    s_nop 3
    buffer_load_dwordx4 v[72:75], v25, s[24:27], s83 offen sc1
    buffer_load_dwordx4 v[76:79], v26, s[24:27], s83 offen sc1
    buffer_load_dword v171, v27, s[24:27], s83 offen sc1
    s_waitcnt vmcnt(0)
    v_add3_u32 v248, v171, v72, v73
    v_add3_u32 v249, v74, v75, v76
    v_add3_u32 v248, v248, v77, v78
    v_add3_u32 v248, v248, v249, v79
    v_cmp_ne_u32 vcc, s61, v248
    s_cbranch_vccnz L_slow33
    buffer_load_dwordx4 v[80:83], v25, s[24:27], s84 offen sc1
    buffer_load_dwordx4 v[84:87], v26, s[24:27], s84 offen sc1
    buffer_load_dword v172, v27, s[24:27], s84 offen sc1
    s_branch L_back33
L_give33:
    s_mov_b32 s60, 0
    s_waitcnt vmcnt(0)
    s_branch L_back33
L_slow34:
    s_sub_u32 s60, s60, 1
    s_cbranch_scc1 L_give34
    s_nop 7
    s_nop 3
    buffer_load_dwordx4 v[80:83], v25, s[24:27], s84 offen sc1
    buffer_load_dwordx4 v[84:87], v26, s[24:27], s84 offen sc1
    buffer_load_dword v172, v27, s[24:27], s84 offen sc1
    s_waitcnt vmcnt(0)
    v_add3_u32 v248, v172, v80, v81
    v_add3_u32 v249, v82, v83, v84
    v_add3_u32 v248, v248, v85, v86
    v_add3_u32 v248, v248, v249, v87
    v_cmp_ne_u32 vcc, s61, v248
    s_cbranch_vccnz L_slow34
    buffer_load_dwordx4 v[88:91], v25, s[24:27], s85 offen sc1
    buffer_load_dwordx4 v[92:95], v26, s[24:27], s85 offen sc1
    buffer_load_dword v173, v27, s[24:27], s85 offen sc1
    s_branch L_back34
L_give34:
    s_mov_b32 s60, 0
    s_waitcnt vmcnt(0)
    s_branch L_back34
L_slow35:
    s_sub_u32 s60, s60, 1
    s_cbranch_scc1 L_give35
    s_nop 7
    s_nop 3
    buffer_load_dwordx4 v[88:91], v25, s[24:27], s85 offen sc1
    buffer_load_dwordx4 v[92:95], v26, s[24:27], s85 offen sc1
    buffer_load_dword v173, v27, s[24:27], s85 offen sc1
    s_waitcnt vmcnt(0)
    v_add3_u32 v248, v173, v88, v89
    v_add3_u32 v249, v90, v91, v92
    v_add3_u32 v248, v248, v93, v94
    v_add3_u32 v248, v248, v249, v95
    v_cmp_ne_u32 vcc, s61, v248
    s_cbranch_vccnz L_slow35
    buffer_load_dwordx4 v[96:99], v25, s[24:27], s86 offen sc1
    buffer_load_dwordx4 v[100:103], v26, s[24:27], s86 offen sc1
    buffer_load_dword v174, v27, s[24:27], s86 offen sc1
    s_branch L_back35
L_give35:
    s_mov_b32 s60, 0
    s_waitcnt vmcnt(0)
    s_branch L_back35
L_slow36:
    s_sub_u32 s60, s60, 1
    s_cbranch_scc1 L_give36
    s_nop 7
    s_nop 3
    buffer_load_dwordx4 v[96:99], v25, s[24:27], s86 offen sc1
    buffer_load_dwordx4 v[100:103], v26, s[24:27], s86 offen sc1
    buffer_load_dword v174, v27, s[24:27], s86 offen sc1
    s_waitcnt vmcnt(0)
    v_add3_u32 v248, v174, v96, v97
    v_add3_u32 v249, v98, v99, v100
    v_add3_u32 v248, v248, v101, v102
    v_add3_u32 v248, v248, v249, v103
    v_cmp_ne_u32 vcc, s61, v248
    s_cbranch_vccnz L_slow36
    s_branch L_back36
L_give36:
    s_mov_b32 s60, 0
    s_waitcnt vmcnt(0)
    s_branch L_back36
L_cend:
.section .rodata,"a"
.p2align 6
.amdhsa_kernel gated_mix__linear_attn_block__dense_activation_gelu__prompt_kernel
  .amdhsa_next_free_vgpr 256
  .amdhsa_next_free_sgpr 102
  .amdhsa_accum_offset 256
  .amdhsa_group_segment_fixed_size 0
  .amdhsa_kernarg_size 96
  .amdhsa_user_sgpr_count 2
  .amdhsa_user_sgpr_kernarg_segment_ptr 1
  .amdhsa_system_sgpr_workgroup_id_x 1
.end_amdhsa_kernel
```
